```python
import torch

def _softmax(x, axis=-1):
    return torch.softmax(x, dim=axis)
def _gelu(x):
    return torch.nn.functional.gelu(x, approximate="tanh")
def _silu(x):
    return torch.nn.functional.silu(x)
def _sigmoid(x):
    return torch.sigmoid(x)
def _layernorm(x, axis=-1, eps=1e-5):
    m = x.mean(dim=axis, keepdim=True)
    v = x.var(dim=axis, keepdim=True, unbiased=False)
    return (x - m) / torch.sqrt(v + eps)
def _scatter_add(tgt, idx, src, axis=0):
    return tgt.clone().index_add_(axis, idx, src)
def _segment_sum(src, seg, n):
    out = torch.zeros((n,) + src.shape[1:], dtype=src.dtype)
    return out.index_add_(0, seg, src)
def _pad(x, pw):
    flat = tuple(v for pair in reversed(pw) for v in pair)
    return torch.nn.functional.pad(x, flat)

kernel_name = 'concat_heads__ssm_conv_s4__linear_attn_block__prompt'

def setup_inputs():

    _w = (lambda a: (lambda t: t.to(torch.bfloat16) if t.is_floating_point() else t)(torch.as_tensor(a)))
    def _A_setup():
        B, L, D, N = 1, 2048, 448, 256
        A_re = -(lambda _x: torch.exp(torch.as_tensor(_x)))((lambda *s: torch.randn(*s, dtype=torch.bfloat16) * 3.2)(D, N))
        A_im = torch.pi * (lambda *s: torch.randn(*s, dtype=torch.bfloat16) * 0.05)(D, N)
        B_re = (lambda *s: torch.randn(*s, dtype=torch.bfloat16) * 0.2)(D, N)
        B_im = (lambda *s: torch.randn(*s, dtype=torch.bfloat16) * 0.2)(D, N)
        C_re = (lambda *s: torch.randn(*s, dtype=torch.bfloat16) * 0.2)(D, N)
        C_im = (lambda *s: torch.randn(*s, dtype=torch.bfloat16) * 0.2)(D, N)
        log_dt = (lambda *s: torch.randn(*s, dtype=torch.bfloat16) * 0.05)(D) * 0.5 - 4.0
        Dskip = (lambda *s: torch.randn(*s, dtype=torch.bfloat16) * 0.05)(D)
        return {
            "u": _w((lambda *s: torch.randn(*s, dtype=torch.bfloat16) * 0.05)(B, L, D)),
            "A_re": _w(A_re),
            "A_im": _w(A_im),
            "B_re": _w(B_re),
            "B_im": _w(B_im),
            "C_re": _w(C_re),
            "C_im": _w(C_im),
            "log_dt": _w(log_dt),
            "Dskip": _w(Dskip),
        }
    _A_in = _A_setup()

    def _B_setup():
        B, S, D = 1, 2048, 448
        return {
            "x": _w((lambda *s: torch.randn(*s, dtype=torch.bfloat16) * 0.05)(B, S, D)),
            "wqkv": _w((lambda *s: torch.randn(*s, dtype=torch.bfloat16) * 0.8)(D, 3 * D)),
            "wo": _w((lambda *s: torch.randn(*s, dtype=torch.bfloat16) * 0.1)(D, D)),
        }
    _B_in = _B_setup()

    return {
        "A_u": _A_in["u"],
        "A_A_re": _A_in["A_re"],
        "A_A_im": _A_in["A_im"],
        "A_B_re": _A_in["B_re"],
        "A_B_im": _A_in["B_im"],
        "A_C_re": _A_in["C_re"],
        "A_C_im": _A_in["C_im"],
        "A_log_dt": _A_in["log_dt"],
        "A_Dskip": _A_in["Dskip"],
        "B_x": _B_in["x"],
        "B_wqkv": _B_in["wqkv"],
        "B_wo": _B_in["wo"],
    }

def reference(A_u, A_A_re, A_A_im, A_B_re, A_B_im, A_C_re, A_C_im, A_log_dt, A_Dskip, B_x, B_wqkv, B_wo):
    def _A_ref(u, A_re, A_im, B_re, B_im, C_re, C_im, log_dt, Dskip):
        Bsz, L, D = u.shape
        dt = torch.exp(log_dt)[:, None]
        A = A_re + 1j * A_im
        Bc = B_re + 1j * B_im
        Cc = C_re + 1j * C_im
        logdA = dt * A
        dB = dt * Bc
        l = (lambda x, dt: x.to(dt))(torch.arange(L), A_re.dtype)
        P = torch.exp(logdA[:, :, None] * l[None, None, :])
        K = torch.einsum("dn,dnl,dn->dl", Cc, P, dB).real
        L2 = 2 * L
        Kp = _pad(K, ((0, 0), (0, L)))
        up = (lambda x, *d: x.permute(*d))(u, 0, 2, 1)
        up = _pad(up, ((0, 0), (0, 0), (0, L)))
        Kf = (lambda x, axes=(-2,-1): torch.fft.rfft2(x.float(), dim=axes))(Kp[:, None, :], axes=(-2, -1))
        Uf = (lambda x, axes=(-2,-1): torch.fft.rfft2(x.float(), dim=axes))(up[:, :, None, :], axes=(-2, -1))
        Yf = Uf * Kf[None, :, :, :]
        y = (lambda x, s, axes=(-2,-1): torch.fft.irfft2(x, s=s, dim=axes).to(torch.bfloat16))(Yf, (1, L2), axes=(-2, -1))[:, :, 0, :L]
        y = (lambda x, *d: x.permute(*d))(y, 0, 2, 1) + u * Dskip[None, None, :]
        return y

    def _B_ref(x, wqkv, wo):
        B, S, D = x.shape
        H = 16; Dh = D // H
        qkv = (lambda x, *d: x.permute(*d))((x @ wqkv).reshape(B, S, 3, H, Dh), 2, 0, 3, 1, 4)
        q, k, v = qkv[0], qkv[1], qkv[2]
        phi = lambda t: torch.where(t > 0, t + 1, torch.exp(t)) + 1e-6
        pq, pk = phi(q), phi(k)
        kv = torch.einsum("bhsd,bhse->bhde", pk, v)
        z = torch.einsum("bhsd->bhd", pk)
        num = torch.einsum("bhqd,bhde->bhqe", pq, kv)
        den = torch.einsum("bhqd,bhd->bhq", pq, z)[..., None] + 1e-6
        o = num / den
        return (lambda x, *d: x.permute(*d))(o, 0, 2, 1, 3).reshape(B, S, D) @ wo

    a = _A_ref(A_u, A_A_re, A_A_im, A_B_re, A_B_im, A_C_re, A_C_im, A_log_dt, A_Dskip)
    b = _B_ref(B_x, B_wqkv, B_wo)
    return torch.concatenate([a, b], axis=-1)
```

```asm
; @launch grid=(512,1,1) block=(256,1,1) lds=81920
.amdgcn_target "amdgcn-amd-amdhsa--gfx950"
.text
.globl concat_heads__ssm_conv_s4__linear_attn_block__prompt_kernel
.p2align 8
.type concat_heads__ssm_conv_s4__linear_attn_block__prompt_kernel,@function
concat_heads__ssm_conv_s4__linear_attn_block__prompt_kernel:
    s_cmp_ge_u32 s2, 512
    s_cbranch_scc1 L_end
    s_load_dwordx8 s[32:39], s[0:1], 64
    s_load_dwordx4 s[40:43], s[0:1], 96
    s_load_dwordx2 s[44:45], s[0:1], 112
    v_lshrrev_b32 v1, 6, v0
    v_and_b32 v2, 63, v0
    v_readfirstlane_b32 s66, v1
    v_lshlrev_b32 v3, 4, v2
    v_mov_b32 v4, 64
    s_mov_b32 s15, 40000
    s_cmp_lt_u32 s2, 256
    s_cbranch_scc1 L_S
    s_sub_u32 s2, s2, 256
    s_setprio 1
    s_and_b32 s67, s2, 7
    s_lshr_b32 s68, s2, 3
    s_lshr_b32 s80, s2, 7
    s_lshr_b32 s72, s67, 1
    s_lshl_b32 s72, s72, 2
    s_bfe_u32 s69, s68, 0x20002
    s_add_u32 s72, s72, s69
    s_and_b32 s73, s67, 1
    s_lshl_b32 s73, s73, 2
    s_and_b32 s70, s68, 3
    s_add_u32 s73, s73, s70
    s_lshl_b32 s74, s70, 1
    s_add_u32 s74, s74, s80
    s_mul_i32 s69, s69, 3
    s_add_u32 s74, s74, s69
    s_cmp_ge_u32 s74, 14
    s_cselect_b32 s69, 14, 0
    s_sub_u32 s74, s74, s69
    s_cmp_ge_u32 s74, 7
    s_cselect_b32 s69, 7, 0
    s_sub_u32 s74, s74, s69
    s_mov_b32 s74, 0
    s_lshl_b32 s76, s74, 7
    s_mul_i32 s77, s74, 172032
    v_lshrrev_b32 v37, 3, v2
    v_and_b32 v38, 7, v2
    v_lshrrev_b32 v39, 4, v2
    v_xor_b32 v42, v38, v39
    v_lshlrev_b32 v42, 4, v42
    v_mul_u32_u24 v43, 896, v37
    s_lshl_b32 s67, s72, 2
    s_add_u32 s67, s67, s66
    s_mul_i32 s67, s67, 28672
    v_add3_u32 v8, v42, v43, s67
    v_xor_b32 v42, 64, v42
    v_add3_u32 v9, v42, v43, s67
    v_add_u32 v9, 6144, v9
    v_add_u32 v10, 12288, v8
    v_add_u32 v11, 12288, v9
    v_and_b32 v42, 1, v39
    v_lshlrev_b32 v42, 2, v42
    v_xor_b32 v44, v42, v38
    v_min_u32 v42, 6, v44
    v_lshlrev_b32 v42, 4, v42
    v_mul_u32_u24 v45, 2688, v37
    s_lshr_b32 s67, s66, 1
    s_add_u32 s67, s67, 1
    s_mul_i32 s67, s67, 896
    s_and_b32 s68, s66, 1
    s_mul_i32 s68, s68, 86016
    s_add_u32 s67, s67, s68
    s_mul_i32 s68, s66, 43008
    s_lshl_b32 s78, s66, 12
    s_lshl_b32 s69, s66, 11
    s_cmp_eq_u32 s80, 0
    s_cselect_b32 s67, s68, s67
    s_cselect_b32 s79, s69, s78
    s_add_u32 s79, s79, 49152
    s_mul_i32 s68, s73, 112
    s_add_u32 s67, s67, s68
    v_add3_u32 v12, v42, v45, s67
    v_add_u32 v13, 20480, v12
    v_add_u32 v14, 40960, v12
    v_add_u32 v15, 61440, v12
    s_mov_b32 s54, 1835008
    s_mov_b32 s55, 0x20000
    s_mov_b32 s58, 1204224
    s_mov_b32 s59, 0x20000
    s_cmp_eq_u32 s80, 0
    s_waitcnt lgkmcnt(0)
    s_mov_b32 s52, s34
    s_mov_b32 s53, s35
    s_mov_b32 s56, s36
    s_mov_b32 s57, s37
    s_cbranch_scc1 L_GQ
    s_add_u32 m0, s78, 0
    s_nop 0
    buffer_load_dwordx4 v8, s[52:55], s76 offen offset:0  lds
    buffer_load_dwordx4 v9, s[52:55], s76 offen offset:1024  lds
    buffer_load_dwordx4 v10, s[52:55], s76 offen offset:2048  lds
    buffer_load_dwordx4 v11, s[52:55], s76 offen offset:3072  lds
    s_add_u32 s76, s76, 128
    s_cmp_eq_u32 s76, 896
    s_cselect_b32 s76, 0, s76
    s_add_u32 m0, s79, 0
    s_nop 0
    buffer_load_dwordx4 v12, s[56:59], s77 offen offset:0  lds
    buffer_load_dwordx4 v13, s[56:59], s77 offen offset:1024  lds
    buffer_load_dwordx4 v14, s[56:59], s77 offen offset:2048  lds
    buffer_load_dwordx4 v15, s[56:59], s77 offen offset:3072  lds
    s_add_u32 s77, s77, 172032
    s_cmp_eq_u32 s77, 1204224
    s_cselect_b32 s77, 0, s77
    s_add_u32 m0, s78, 16384
    s_nop 0
    buffer_load_dwordx4 v8, s[52:55], s76 offen offset:0  lds
    buffer_load_dwordx4 v9, s[52:55], s76 offen offset:1024  lds
    buffer_load_dwordx4 v10, s[52:55], s76 offen offset:2048  lds
    buffer_load_dwordx4 v11, s[52:55], s76 offen offset:3072  lds
    s_add_u32 s76, s76, 128
    s_cmp_eq_u32 s76, 896
    s_cselect_b32 s76, 0, s76
    s_add_u32 m0, s79, 16384
    s_nop 0
    buffer_load_dwordx4 v12, s[56:59], s77 offen offset:0  lds
    buffer_load_dwordx4 v13, s[56:59], s77 offen offset:1024  lds
    buffer_load_dwordx4 v14, s[56:59], s77 offen offset:2048  lds
    buffer_load_dwordx4 v15, s[56:59], s77 offen offset:3072  lds
    s_add_u32 s77, s77, 172032
    s_cmp_eq_u32 s77, 1204224
    s_cselect_b32 s77, 0, s77
    v_and_b32 v42, 31, v2
    v_lshrrev_b32 v40, 5, v2
    v_bfe_u32 v41, v2, 1, 3
    v_xor_b32 v41, v41, v40
    v_lshlrev_b32 v41, 4, v41
    v_lshl_add_u32 v41, v42, 7, v41
    s_lshr_b32 s67, s66, 1
    s_lshl_b32 s67, s67, 13
    v_add_u32 v16, s67, v41
    v_xor_b32 v17, 32, v16
    v_xor_b32 v18, 64, v16
    v_xor_b32 v19, 96, v16
    v_bfe_u32 v41, v2, 2, 2
    v_lshl_add_u32 v41, v40, 3, v41
    v_lshlrev_b32 v41, 7, v41
    v_and_b32 v45, 3, v2
    v_lshlrev_b32 v46, 3, v45
    v_bfe_u32 v47, v2, 4, 1
    v_lshl_add_u32 v46, v47, 5, v46
    s_and_b32 s67, s66, 1
    s_mul_i32 s67, s67, 56
    v_add_u32 v46, s67, v46
    v_bfe_u32 v47, v2, 3, 1
    v_lshlrev_b32 v47, 6, v47
    v_xor_b32 v46, v46, v47
    v_add_u32 v41, v41, v46
    v_add_u32 v20, 49152, v41
    s_and_b32 s67, s2, 31
    s_lshl_b32 s67, s67, 4
    s_lshl_b32 s68, s66, 2
    s_add_u32 s67, s67, s68
    s_lshl_b32 s67, s67, 7
    s_add_u32 s67, s67, 2392064
    v_lshlrev_b32 v45, 7, v45
    v_add_u32 v22, s67, v45
    s_lshl_b32 s67, s66, 12
    s_add_u32 s67, s67, 2457600
    v_lshlrev_b32 v23, 7, v42
    v_add_u32 v23, s67, v23
    v_lshlrev_b32 v44, 4, v44
    s_mul_i32 s67, s66, 100352
    s_lshr_b32 s68, s2, 5
    s_lshl_b32 s68, s68, 7
    s_add_u32 s67, s67, s68
    v_add3_u32 v21, v44, v43, s67
    v_add_u32 v24, s78, v3
    v_add_u32 v25, s79, v3
    s_mov_b32 s64, 1069066811
    s_mov_b32 s65, 1069066811
    s_mov_b32 s48, s44
    s_mov_b32 s49, s45
    s_mov_b32 s50, 7340032
    s_mov_b32 s51, 0x20000
    s_mov_b32 s60, s40
    s_mov_b32 s61, s41
    s_mov_b32 s62, 3670016
    s_mov_b32 s63, 0x20000
    s_memrealtime s[12:13]
    s_mul_i32 s67, s66, 20480
    s_add_u32 s67, s67, 16384
    v_add_u32 v5, s67, v3
    s_and_b32 s67, s66, 1
    s_lshr_b32 s68, s66, 1
    s_lshl_b32 s68, s68, 11
    s_mul_i32 s69, s67, 20480
    s_add_u32 s69, s69, s68
    s_add_u32 s69, s69, 16384
    s_and_b32 s70, s72, 7
    s_lshl_b32 s70, s70, 8
    s_add_u32 s70, s70, s69
    v_lshlrev_b32 v40, 2, v2
    v_add_u32 v28, s70, v40
    s_lshl_b32 s67, s67, 12
    s_add_u32 s67, s67, s68
    s_lshl_b32 s81, s73, 13
    s_add_u32 s81, s81, s67
    s_add_u32 s81, s81, 2097152
    s_sub_u32 s81, s81, s69
    s_lshl_b32 s75, s73, 4
    s_add_u32 s75, s75, s72
    s_lshl_b32 s75, s75, 7
    s_add_u32 s75, s75, 2457600
    v_xor_b32 v29, 256, v28
    v_xor_b32 v30, 512, v28
    v_xor_b32 v31, 768, v28
    v_xor_b32 v32, 1024, v28
    v_xor_b32 v33, 1280, v28
    v_xor_b32 v34, 1536, v28
    v_xor_b32 v35, 1792, v28
    s_lshr_b32 s67, s66, 1
    s_lshl_b32 s67, s67, 3
    s_and_b32 s68, s72, 7
    s_or_b32 s67, s67, s68
    s_xor_b32 s68, s67, 0
    s_cmp_ge_u32 s68, 14
    s_cselect_b32 s68, 0x7fff0000, 0
    v_add_u32 v28, s68, v28
    s_xor_b32 s68, s67, 1
    s_cmp_ge_u32 s68, 14
    s_cselect_b32 s68, 0x7fff0000, 0
    v_add_u32 v29, s68, v29
    s_xor_b32 s68, s67, 2
    s_cmp_ge_u32 s68, 14
    s_cselect_b32 s68, 0x7fff0000, 0
    v_add_u32 v30, s68, v30
    s_xor_b32 s68, s67, 3
    s_cmp_ge_u32 s68, 14
    s_cselect_b32 s68, 0x7fff0000, 0
    v_add_u32 v31, s68, v31
    s_xor_b32 s68, s67, 4
    s_cmp_ge_u32 s68, 14
    s_cselect_b32 s68, 0x7fff0000, 0
    v_add_u32 v32, s68, v32
    s_xor_b32 s68, s67, 5
    s_cmp_ge_u32 s68, 14
    s_cselect_b32 s68, 0x7fff0000, 0
    v_add_u32 v33, s68, v33
    s_xor_b32 s68, s67, 6
    s_cmp_ge_u32 s68, 14
    s_cselect_b32 s68, 0x7fff0000, 0
    v_add_u32 v34, s68, v34
    s_xor_b32 s68, s67, 7
    s_cmp_ge_u32 s68, 14
    s_cselect_b32 s68, 0x7fff0000, 0
    v_add_u32 v35, s68, v35
    v_and_b32 v6, 3, v2
    v_lshlrev_b32 v6, 7, v6
    v_add_u32 v6, 2473984, v6
    v_mov_b32 v64, 0x358637bd
    v_mov_b32 v65, 0x358637bd
    v_mov_b32 v66, 0x358637bd
    v_mov_b32 v67, 0x358637bd
    v_mov_b32 v68, 0x358637bd
    v_mov_b32 v69, 0x358637bd
    v_mov_b32 v70, 0x358637bd
    v_mov_b32 v71, 0x358637bd
    v_mov_b32 v72, 0x358637bd
    v_mov_b32 v73, 0x358637bd
    v_mov_b32 v74, 0x358637bd
    v_mov_b32 v75, 0x358637bd
    v_mov_b32 v76, 0x358637bd
    v_mov_b32 v77, 0x358637bd
    v_mov_b32 v78, 0x358637bd
    v_mov_b32 v79, 0x358637bd
    v_mov_b32 v80, 0x358637bd
    v_mov_b32 v81, 0x358637bd
    v_mov_b32 v82, 0x358637bd
    v_mov_b32 v83, 0x358637bd
    v_mov_b32 v84, 0x358637bd
    v_mov_b32 v85, 0x358637bd
    v_mov_b32 v86, 0x358637bd
    v_mov_b32 v87, 0x358637bd
    v_mov_b32 v88, 0x358637bd
    v_mov_b32 v89, 0x358637bd
    v_mov_b32 v90, 0x358637bd
    v_mov_b32 v91, 0x358637bd
    v_mov_b32 v92, 0x358637bd
    v_mov_b32 v93, 0x358637bd
    v_mov_b32 v94, 0x358637bd
    v_mov_b32 v95, 0x358637bd
    s_waitcnt vmcnt(8)
    s_barrier
    ds_read_b64_tr_b16 v[144:145], v20 offset:0
    ds_read_b64_tr_b16 v[146:147], v20 offset:512
    ds_read_b64_tr_b16 v[148:149], v20 offset:8192
    ds_read_b64_tr_b16 v[150:151], v20 offset:8704
    ds_read_b128 v[128:131], v16 offset:0
    ds_read_b128 v[132:135], v16 offset:4096
    ds_read_b64_tr_b16 v[152:153], v20 offset:2048
    ds_read_b64_tr_b16 v[154:155], v20 offset:2560
    ds_read_b64_tr_b16 v[156:157], v20 offset:10240
    ds_read_b64_tr_b16 v[158:159], v20 offset:10752
    ds_read_b128 v[136:139], v17 offset:0
    ds_read_b128 v[140:143], v17 offset:4096
    s_waitcnt lgkmcnt(6)
    v_mfma_f32_32x32x16_bf16 v[64:79], v[128:131], v[144:147], v[64:79]
    buffer_load_dwordx4 a[0:3], v12, s[56:59], s77 offen offset:0
    v_mfma_f32_32x32x16_bf16 v[80:95], v[132:135], v[144:147], v[80:95]
    buffer_load_dwordx4 a[4:7], v13, s[56:59], s77 offen offset:1024
    v_mfma_f32_32x32x16_bf16 v[96:111], v[128:131], v[148:151], 0
    buffer_load_dwordx4 a[8:11], v14, s[56:59], s77 offen offset:2048
    v_mfma_f32_32x32x16_bf16 v[112:127], v[132:135], v[148:151], 0
    buffer_load_dwordx4 a[12:15], v15, s[56:59], s77 offen offset:3072
    s_add_u32 s77, s77, 172032
    s_cmp_eq_u32 s77, 1204224
    s_cselect_b32 s77, 0, s77
    ds_read_b64_tr_b16 v[144:145], v20 offset:4096
    ds_read_b64_tr_b16 v[146:147], v20 offset:4608
    ds_read_b64_tr_b16 v[148:149], v20 offset:12288
    ds_read_b64_tr_b16 v[150:151], v20 offset:12800
    ds_read_b128 v[128:131], v18 offset:0
    ds_read_b128 v[132:135], v18 offset:4096
    s_waitcnt lgkmcnt(6)
    v_mfma_f32_32x32x16_bf16 v[64:79], v[136:139], v[152:155], v[64:79]
    s_add_u32 m0, s78, 32768
    s_nop 0
    buffer_load_dwordx4 v8, s[52:55], s76 offen offset:0  lds
    v_mfma_f32_32x32x16_bf16 v[80:95], v[140:143], v[152:155], v[80:95]
    buffer_load_dwordx4 v9, s[52:55], s76 offen offset:1024  lds
    v_mfma_f32_32x32x16_bf16 v[96:111], v[136:139], v[156:159], v[96:111]
    buffer_load_dwordx4 v10, s[52:55], s76 offen offset:2048  lds
    v_mfma_f32_32x32x16_bf16 v[112:127], v[140:143], v[156:159], v[112:127]
    buffer_load_dwordx4 v11, s[52:55], s76 offen offset:3072  lds
    s_add_u32 s76, s76, 128
    s_cmp_eq_u32 s76, 896
    s_cselect_b32 s76, 0, s76
    ds_read_b64_tr_b16 v[152:153], v20 offset:6144
    ds_read_b64_tr_b16 v[154:155], v20 offset:6656
    ds_read_b64_tr_b16 v[156:157], v20 offset:14336
    ds_read_b64_tr_b16 v[158:159], v20 offset:14848
    ds_read_b128 v[136:139], v19 offset:0
    ds_read_b128 v[140:143], v19 offset:4096
    s_waitcnt lgkmcnt(6)
    v_mfma_f32_32x32x16_bf16 v[64:79], v[128:131], v[144:147], v[64:79]
    buffer_load_dwordx4 a[16:19], v12, s[56:59], s77 offen offset:0
    v_mfma_f32_32x32x16_bf16 v[80:95], v[132:135], v[144:147], v[80:95]
    buffer_load_dwordx4 a[20:23], v13, s[56:59], s77 offen offset:1024
    v_mfma_f32_32x32x16_bf16 v[96:111], v[128:131], v[148:151], v[96:111]
    buffer_load_dwordx4 a[24:27], v14, s[56:59], s77 offen offset:2048
    v_mfma_f32_32x32x16_bf16 v[112:127], v[132:135], v[148:151], v[112:127]
    buffer_load_dwordx4 a[28:31], v15, s[56:59], s77 offen offset:3072
    s_add_u32 s77, s77, 172032
    s_cmp_eq_u32 s77, 1204224
    s_cselect_b32 s77, 0, s77
    s_waitcnt vmcnt(12) lgkmcnt(0)
    s_barrier
    ds_read_b64_tr_b16 v[144:145], v20 offset:16384
    ds_read_b64_tr_b16 v[146:147], v20 offset:16896
    ds_read_b64_tr_b16 v[148:149], v20 offset:24576
    ds_read_b64_tr_b16 v[150:151], v20 offset:25088
    ds_read_b128 v[128:131], v16 offset:16384
    ds_read_b128 v[132:135], v16 offset:20480
    v_mfma_f32_32x32x16_bf16 v[64:79], v[136:139], v[152:155], v[64:79]
    s_waitcnt vmcnt(8)
    ds_write_b128 v25, a[0:3] offset:0
    v_mfma_f32_32x32x16_bf16 v[80:95], v[140:143], v[152:155], v[80:95]
    v_mfma_f32_32x32x16_bf16 v[96:111], v[136:139], v[156:159], v[96:111]
    v_mfma_f32_32x32x16_bf16 v[112:127], v[140:143], v[156:159], v[112:127]
    ds_read_b64_tr_b16 v[152:153], v20 offset:18432
    ds_read_b64_tr_b16 v[154:155], v20 offset:18944
    ds_read_b64_tr_b16 v[156:157], v20 offset:26624
    ds_read_b64_tr_b16 v[158:159], v20 offset:27136
    ds_read_b128 v[136:139], v17 offset:16384
    ds_read_b128 v[140:143], v17 offset:20480
    s_waitcnt lgkmcnt(7)
    v_mfma_f32_32x32x16_bf16 v[64:79], v[128:131], v[144:147], v[64:79]
    s_add_u32 m0, s78, 0
    s_nop 0
    buffer_load_dwordx4 v8, s[52:55], s76 offen offset:0  lds
    v_mfma_f32_32x32x16_bf16 v[80:95], v[132:135], v[144:147], v[80:95]
    buffer_load_dwordx4 v9, s[52:55], s76 offen offset:1024  lds
    v_mfma_f32_32x32x16_bf16 v[96:111], v[128:131], v[148:151], v[96:111]
    buffer_load_dwordx4 v10, s[52:55], s76 offen offset:2048  lds
    v_mfma_f32_32x32x16_bf16 v[112:127], v[132:135], v[148:151], v[112:127]
    ds_write_b128 v25, a[4:7] offset:1024
    ds_read_b64_tr_b16 v[144:145], v20 offset:20480
    ds_read_b64_tr_b16 v[146:147], v20 offset:20992
    ds_read_b64_tr_b16 v[148:149], v20 offset:28672
    ds_read_b64_tr_b16 v[150:151], v20 offset:29184
    ds_read_b128 v[128:131], v18 offset:16384
    ds_read_b128 v[132:135], v18 offset:20480
    s_waitcnt lgkmcnt(7)
    v_mfma_f32_32x32x16_bf16 v[64:79], v[136:139], v[152:155], v[64:79]
    buffer_load_dwordx4 v11, s[52:55], s76 offen offset:3072  lds
    s_add_u32 s76, s76, 128
    s_cmp_eq_u32 s76, 896
    s_cselect_b32 s76, 0, s76
    v_mfma_f32_32x32x16_bf16 v[80:95], v[140:143], v[152:155], v[80:95]
    buffer_load_dwordx4 a[32:35], v12, s[56:59], s77 offen offset:0
    v_mfma_f32_32x32x16_bf16 v[96:111], v[136:139], v[156:159], v[96:111]
    buffer_load_dwordx4 a[36:39], v13, s[56:59], s77 offen offset:1024
    v_mfma_f32_32x32x16_bf16 v[112:127], v[140:143], v[156:159], v[112:127]
    ds_write_b128 v25, a[8:11] offset:2048
    ds_read_b64_tr_b16 v[152:153], v20 offset:22528
    ds_read_b64_tr_b16 v[154:155], v20 offset:23040
    ds_read_b64_tr_b16 v[156:157], v20 offset:30720
    ds_read_b64_tr_b16 v[158:159], v20 offset:31232
    ds_read_b128 v[136:139], v19 offset:16384
    ds_read_b128 v[140:143], v19 offset:20480
    s_waitcnt lgkmcnt(7)
    v_mfma_f32_32x32x16_bf16 v[64:79], v[128:131], v[144:147], v[64:79]
    buffer_load_dwordx4 a[40:43], v14, s[56:59], s77 offen offset:2048
    v_mfma_f32_32x32x16_bf16 v[80:95], v[132:135], v[144:147], v[80:95]
    buffer_load_dwordx4 a[44:47], v15, s[56:59], s77 offen offset:3072
    s_add_u32 s77, s77, 172032
    s_cmp_eq_u32 s77, 1204224
    s_cselect_b32 s77, 0, s77
    v_mfma_f32_32x32x16_bf16 v[96:111], v[128:131], v[148:151], v[96:111]
    ds_write_b128 v25, a[12:15] offset:3072
    v_mfma_f32_32x32x16_bf16 v[112:127], v[132:135], v[148:151], v[112:127]
    s_waitcnt vmcnt(12) lgkmcnt(0)
    s_barrier
    ds_read_b64_tr_b16 v[144:145], v20 offset:0
    ds_read_b64_tr_b16 v[146:147], v20 offset:512
    ds_read_b64_tr_b16 v[148:149], v20 offset:8192
    ds_read_b64_tr_b16 v[150:151], v20 offset:8704
    ds_read_b128 v[128:131], v16 offset:32768
    ds_read_b128 v[132:135], v16 offset:36864
    v_mfma_f32_32x32x16_bf16 v[64:79], v[136:139], v[152:155], v[64:79]
    s_waitcnt vmcnt(8)
    ds_write_b128 v25, a[16:19] offset:16384
    v_mfma_f32_32x32x16_bf16 v[80:95], v[140:143], v[152:155], v[80:95]
    v_mfma_f32_32x32x16_bf16 v[96:111], v[136:139], v[156:159], v[96:111]
    v_mfma_f32_32x32x16_bf16 v[112:127], v[140:143], v[156:159], v[112:127]
    ds_read_b64_tr_b16 v[152:153], v20 offset:2048
    ds_read_b64_tr_b16 v[154:155], v20 offset:2560
    ds_read_b64_tr_b16 v[156:157], v20 offset:10240
    ds_read_b64_tr_b16 v[158:159], v20 offset:10752
    ds_read_b128 v[136:139], v17 offset:32768
    ds_read_b128 v[140:143], v17 offset:36864
    s_waitcnt lgkmcnt(7)
    v_mfma_f32_32x32x16_bf16 v[64:79], v[128:131], v[144:147], v[64:79]
    s_add_u32 m0, s78, 16384
    s_nop 0
    buffer_load_dwordx4 v8, s[52:55], s76 offen offset:0  lds
    v_mfma_f32_32x32x16_bf16 v[80:95], v[132:135], v[144:147], v[80:95]
    buffer_load_dwordx4 v9, s[52:55], s76 offen offset:1024  lds
    v_mfma_f32_32x32x16_bf16 v[96:111], v[128:131], v[148:151], v[96:111]
    buffer_load_dwordx4 v10, s[52:55], s76 offen offset:2048  lds
    v_mfma_f32_32x32x16_bf16 v[112:127], v[132:135], v[148:151], v[112:127]
    ds_write_b128 v25, a[20:23] offset:17408
    ds_read_b64_tr_b16 v[144:145], v20 offset:4096
    ds_read_b64_tr_b16 v[146:147], v20 offset:4608
    ds_read_b64_tr_b16 v[148:149], v20 offset:12288
    ds_read_b64_tr_b16 v[150:151], v20 offset:12800
    ds_read_b128 v[128:131], v18 offset:32768
    ds_read_b128 v[132:135], v18 offset:36864
    s_waitcnt lgkmcnt(7)
    v_mfma_f32_32x32x16_bf16 v[64:79], v[136:139], v[152:155], v[64:79]
    buffer_load_dwordx4 v11, s[52:55], s76 offen offset:3072  lds
    s_add_u32 s76, s76, 128
    s_cmp_eq_u32 s76, 896
    s_cselect_b32 s76, 0, s76
    v_mfma_f32_32x32x16_bf16 v[80:95], v[140:143], v[152:155], v[80:95]
    buffer_load_dwordx4 a[0:3], v12, s[56:59], s77 offen offset:0
    v_mfma_f32_32x32x16_bf16 v[96:111], v[136:139], v[156:159], v[96:111]
    buffer_load_dwordx4 a[4:7], v13, s[56:59], s77 offen offset:1024
    v_mfma_f32_32x32x16_bf16 v[112:127], v[140:143], v[156:159], v[112:127]
    ds_write_b128 v25, a[24:27] offset:18432
    ds_read_b64_tr_b16 v[152:153], v20 offset:6144
    ds_read_b64_tr_b16 v[154:155], v20 offset:6656
    ds_read_b64_tr_b16 v[156:157], v20 offset:14336
    ds_read_b64_tr_b16 v[158:159], v20 offset:14848
    ds_read_b128 v[136:139], v19 offset:32768
    ds_read_b128 v[140:143], v19 offset:36864
    s_waitcnt lgkmcnt(7)
    v_mfma_f32_32x32x16_bf16 v[64:79], v[128:131], v[144:147], v[64:79]
    buffer_load_dwordx4 a[8:11], v14, s[56:59], s77 offen offset:2048
    v_mfma_f32_32x32x16_bf16 v[80:95], v[132:135], v[144:147], v[80:95]
    buffer_load_dwordx4 a[12:15], v15, s[56:59], s77 offen offset:3072
    s_add_u32 s77, s77, 172032
    s_cmp_eq_u32 s77, 1204224
    s_cselect_b32 s77, 0, s77
    v_mfma_f32_32x32x16_bf16 v[96:111], v[128:131], v[148:151], v[96:111]
    ds_write_b128 v25, a[28:31] offset:19456
    v_mfma_f32_32x32x16_bf16 v[112:127], v[132:135], v[148:151], v[112:127]
    s_waitcnt vmcnt(12) lgkmcnt(0)
    s_barrier
    ds_read_b64_tr_b16 v[144:145], v20 offset:16384
    ds_read_b64_tr_b16 v[146:147], v20 offset:16896
    ds_read_b64_tr_b16 v[148:149], v20 offset:24576
    ds_read_b64_tr_b16 v[150:151], v20 offset:25088
    ds_read_b128 v[128:131], v16 offset:0
    ds_read_b128 v[132:135], v16 offset:4096
    v_mfma_f32_32x32x16_bf16 v[64:79], v[136:139], v[152:155], v[64:79]
    s_waitcnt vmcnt(8)
    ds_write_b128 v25, a[32:35] offset:0
    v_mfma_f32_32x32x16_bf16 v[80:95], v[140:143], v[152:155], v[80:95]
    v_mfma_f32_32x32x16_bf16 v[96:111], v[136:139], v[156:159], v[96:111]
    v_mfma_f32_32x32x16_bf16 v[112:127], v[140:143], v[156:159], v[112:127]
    ds_read_b64_tr_b16 v[152:153], v20 offset:18432
    ds_read_b64_tr_b16 v[154:155], v20 offset:18944
    ds_read_b64_tr_b16 v[156:157], v20 offset:26624
    ds_read_b64_tr_b16 v[158:159], v20 offset:27136
    ds_read_b128 v[136:139], v17 offset:0
    ds_read_b128 v[140:143], v17 offset:4096
    s_waitcnt lgkmcnt(7)
    v_mfma_f32_32x32x16_bf16 v[64:79], v[128:131], v[144:147], v[64:79]
    s_add_u32 m0, s78, 32768
    s_nop 0
    buffer_load_dwordx4 v8, s[52:55], s76 offen offset:0  lds
    v_mfma_f32_32x32x16_bf16 v[80:95], v[132:135], v[144:147], v[80:95]
    buffer_load_dwordx4 v9, s[52:55], s76 offen offset:1024  lds
    v_mfma_f32_32x32x16_bf16 v[96:111], v[128:131], v[148:151], v[96:111]
    buffer_load_dwordx4 v10, s[52:55], s76 offen offset:2048  lds
    v_mfma_f32_32x32x16_bf16 v[112:127], v[132:135], v[148:151], v[112:127]
    ds_write_b128 v25, a[36:39] offset:1024
    ds_read_b64_tr_b16 v[144:145], v20 offset:20480
    ds_read_b64_tr_b16 v[146:147], v20 offset:20992
    ds_read_b64_tr_b16 v[148:149], v20 offset:28672
    ds_read_b64_tr_b16 v[150:151], v20 offset:29184
    ds_read_b128 v[128:131], v18 offset:0
    ds_read_b128 v[132:135], v18 offset:4096
    s_waitcnt lgkmcnt(7)
    v_mfma_f32_32x32x16_bf16 v[64:79], v[136:139], v[152:155], v[64:79]
    buffer_load_dwordx4 v11, s[52:55], s76 offen offset:3072  lds
    s_add_u32 s76, s76, 128
    s_cmp_eq_u32 s76, 896
    s_cselect_b32 s76, 0, s76
    v_mfma_f32_32x32x16_bf16 v[80:95], v[140:143], v[152:155], v[80:95]
    buffer_load_dwordx4 a[16:19], v12, s[56:59], s77 offen offset:0
    v_mfma_f32_32x32x16_bf16 v[96:111], v[136:139], v[156:159], v[96:111]
    buffer_load_dwordx4 a[20:23], v13, s[56:59], s77 offen offset:1024
    v_mfma_f32_32x32x16_bf16 v[112:127], v[140:143], v[156:159], v[112:127]
    ds_write_b128 v25, a[40:43] offset:2048
    ds_read_b64_tr_b16 v[152:153], v20 offset:22528
    ds_read_b64_tr_b16 v[154:155], v20 offset:23040
    ds_read_b64_tr_b16 v[156:157], v20 offset:30720
    ds_read_b64_tr_b16 v[158:159], v20 offset:31232
    ds_read_b128 v[136:139], v19 offset:0
    ds_read_b128 v[140:143], v19 offset:4096
    s_waitcnt lgkmcnt(7)
    v_mfma_f32_32x32x16_bf16 v[64:79], v[128:131], v[144:147], v[64:79]
    buffer_load_dwordx4 a[24:27], v14, s[56:59], s77 offen offset:2048
    v_mfma_f32_32x32x16_bf16 v[80:95], v[132:135], v[144:147], v[80:95]
    buffer_load_dwordx4 a[28:31], v15, s[56:59], s77 offen offset:3072
    s_add_u32 s77, s77, 172032
    s_cmp_eq_u32 s77, 1204224
    s_cselect_b32 s77, 0, s77
    v_mfma_f32_32x32x16_bf16 v[96:111], v[128:131], v[148:151], v[96:111]
    global_load_dwordx2 v[46:47], v4, s[42:43] sc1
    v_mfma_f32_32x32x16_bf16 v[112:127], v[132:135], v[148:151], v[112:127]
    ds_write_b128 v25, a[44:47] offset:3072
    s_waitcnt vmcnt(13) lgkmcnt(0)
    s_barrier
    ds_read_b64_tr_b16 v[144:145], v20 offset:0
    ds_read_b64_tr_b16 v[146:147], v20 offset:512
    ds_read_b64_tr_b16 v[148:149], v20 offset:8192
    ds_read_b64_tr_b16 v[150:151], v20 offset:8704
    ds_read_b128 v[128:131], v16 offset:16384
    ds_read_b128 v[132:135], v16 offset:20480
    v_mfma_f32_32x32x16_bf16 v[64:79], v[136:139], v[152:155], v[64:79]
    s_waitcnt vmcnt(9)
    ds_write_b128 v25, a[0:3] offset:16384
    v_mfma_f32_32x32x16_bf16 v[80:95], v[140:143], v[152:155], v[80:95]
    v_mfma_f32_32x32x16_bf16 v[96:111], v[136:139], v[156:159], v[96:111]
    v_mfma_f32_32x32x16_bf16 v[112:127], v[140:143], v[156:159], v[112:127]
    ds_read_b64_tr_b16 v[152:153], v20 offset:2048
    ds_read_b64_tr_b16 v[154:155], v20 offset:2560
    ds_read_b64_tr_b16 v[156:157], v20 offset:10240
    ds_read_b64_tr_b16 v[158:159], v20 offset:10752
    ds_read_b128 v[136:139], v17 offset:16384
    ds_read_b128 v[140:143], v17 offset:20480
    s_waitcnt lgkmcnt(7)
    v_mfma_f32_32x32x16_bf16 v[64:79], v[128:131], v[144:147], v[64:79]
    s_add_u32 m0, s78, 0
    s_nop 0
    buffer_load_dwordx4 v8, s[52:55], s76 offen offset:0  lds
    v_mfma_f32_32x32x16_bf16 v[80:95], v[132:135], v[144:147], v[80:95]
    buffer_load_dwordx4 v9, s[52:55], s76 offen offset:1024  lds
    v_mfma_f32_32x32x16_bf16 v[96:111], v[128:131], v[148:151], v[96:111]
    ds_write_b128 v25, a[4:7] offset:17408
    v_mfma_f32_32x32x16_bf16 v[112:127], v[132:135], v[148:151], v[112:127]
    ds_read_b64_tr_b16 v[144:145], v20 offset:4096
    ds_read_b64_tr_b16 v[146:147], v20 offset:4608
    ds_read_b64_tr_b16 v[148:149], v20 offset:12288
    ds_read_b64_tr_b16 v[150:151], v20 offset:12800
    ds_read_b128 v[128:131], v18 offset:16384
    ds_read_b128 v[132:135], v18 offset:20480
    s_waitcnt lgkmcnt(7)
    v_mfma_f32_32x32x16_bf16 v[64:79], v[136:139], v[152:155], v[64:79]
    buffer_load_dwordx4 v10, s[52:55], s76 offen offset:2048  lds
    v_mfma_f32_32x32x16_bf16 v[80:95], v[140:143], v[152:155], v[80:95]
    buffer_load_dwordx4 v11, s[52:55], s76 offen offset:3072  lds
    s_add_u32 s76, s76, 128
    s_cmp_eq_u32 s76, 896
    s_cselect_b32 s76, 0, s76
    v_mfma_f32_32x32x16_bf16 v[96:111], v[136:139], v[156:159], v[96:111]
    ds_write_b128 v25, a[8:11] offset:18432
    v_mfma_f32_32x32x16_bf16 v[112:127], v[140:143], v[156:159], v[112:127]
    ds_read_b64_tr_b16 v[152:153], v20 offset:6144
    ds_read_b64_tr_b16 v[154:155], v20 offset:6656
    ds_read_b64_tr_b16 v[156:157], v20 offset:14336
    ds_read_b64_tr_b16 v[158:159], v20 offset:14848
    ds_read_b128 v[136:139], v19 offset:16384
    ds_read_b128 v[140:143], v19 offset:20480
    s_waitcnt lgkmcnt(7)
    v_mfma_f32_32x32x16_bf16 v[64:79], v[128:131], v[144:147], v[64:79]
    ds_write_b128 v25, a[12:15] offset:19456
    v_mfma_f32_32x32x16_bf16 v[80:95], v[132:135], v[144:147], v[80:95]
    v_mfma_f32_32x32x16_bf16 v[96:111], v[128:131], v[148:151], v[96:111]
    v_mfma_f32_32x32x16_bf16 v[112:127], v[132:135], v[148:151], v[112:127]
    s_waitcnt vmcnt(9) lgkmcnt(0)
    s_barrier
    ds_read_b64_tr_b16 v[144:145], v20 offset:16384
    ds_read_b64_tr_b16 v[146:147], v20 offset:16896
    ds_read_b64_tr_b16 v[148:149], v20 offset:24576
    ds_read_b64_tr_b16 v[150:151], v20 offset:25088
    ds_read_b128 v[128:131], v16 offset:32768
    ds_read_b128 v[132:135], v16 offset:36864
    v_mfma_f32_32x32x16_bf16 v[64:79], v[136:139], v[152:155], v[64:79]
    s_waitcnt vmcnt(5)
    ds_write_b128 v25, a[16:19] offset:0
    v_mfma_f32_32x32x16_bf16 v[80:95], v[140:143], v[152:155], v[80:95]
    v_mfma_f32_32x32x16_bf16 v[96:111], v[136:139], v[156:159], v[96:111]
    v_mfma_f32_32x32x16_bf16 v[112:127], v[140:143], v[156:159], v[112:127]
    ds_read_b64_tr_b16 v[152:153], v20 offset:18432
    ds_read_b64_tr_b16 v[154:155], v20 offset:18944
    ds_read_b64_tr_b16 v[156:157], v20 offset:26624
    ds_read_b64_tr_b16 v[158:159], v20 offset:27136
    ds_read_b128 v[136:139], v17 offset:32768
    ds_read_b128 v[140:143], v17 offset:36864
    s_waitcnt lgkmcnt(7)
    v_mfma_f32_32x32x16_bf16 v[64:79], v[128:131], v[144:147], v[64:79]
    s_waitcnt vmcnt(4)
    s_waitcnt lgkmcnt(0)
    s_mov_b32 s13, 200
Li_1:
    v_readfirstlane_b32 s46, v46
    v_readfirstlane_b32 s47, v47
    s_sub_u32 s3, s46, s12
    s_cmp_eq_u32 s46, 0
    s_cbranch_scc1 Lir_3
    s_cmp_gt_i32 s3, -900
    s_cbranch_scc1 Lio_2
    s_sub_u32 s13, s13, 1
    s_cbranch_scc1 Lio_2
Lir_3:
    s_sub_u32 s15, s15, 1
    s_cbranch_scc1 L_end
    s_sleep 1
    global_load_dwordx2 v[46:47], v4, s[42:43] sc1
    s_waitcnt vmcnt(0)
    s_branch Li_1
Lio_2:
    buffer_load_dwordx2 v[26:27], v6, s[48:51], 0 offen sc1
    v_mfma_f32_32x32x16_bf16 v[80:95], v[132:135], v[144:147], v[80:95]
    v_mfma_f32_32x32x16_bf16 v[96:111], v[128:131], v[148:151], v[96:111]
    ds_write_b128 v25, a[20:23] offset:1024
    v_mfma_f32_32x32x16_bf16 v[112:127], v[132:135], v[148:151], v[112:127]
    ds_read_b64_tr_b16 v[144:145], v20 offset:20480
    ds_read_b64_tr_b16 v[146:147], v20 offset:20992
    ds_read_b64_tr_b16 v[148:149], v20 offset:28672
    ds_read_b64_tr_b16 v[150:151], v20 offset:29184
    ds_read_b128 v[128:131], v18 offset:32768
    ds_read_b128 v[132:135], v18 offset:36864
    s_waitcnt lgkmcnt(7)
    v_mfma_f32_32x32x16_bf16 v[64:79], v[136:139], v[152:155], v[64:79]
    ds_write_b128 v25, a[24:27] offset:2048
    v_mfma_f32_32x32x16_bf16 v[80:95], v[140:143], v[152:155], v[80:95]
    v_mfma_f32_32x32x16_bf16 v[96:111], v[136:139], v[156:159], v[96:111]
    v_mfma_f32_32x32x16_bf16 v[112:127], v[140:143], v[156:159], v[112:127]
    ds_read_b64_tr_b16 v[152:153], v20 offset:22528
    ds_read_b64_tr_b16 v[154:155], v20 offset:23040
    ds_read_b64_tr_b16 v[156:157], v20 offset:30720
    ds_read_b64_tr_b16 v[158:159], v20 offset:31232
    ds_read_b128 v[136:139], v19 offset:32768
    ds_read_b128 v[140:143], v19 offset:36864
    s_waitcnt lgkmcnt(7)
    v_mfma_f32_32x32x16_bf16 v[64:79], v[128:131], v[144:147], v[64:79]
    ds_write_b128 v25, a[28:31] offset:3072
    v_mfma_f32_32x32x16_bf16 v[80:95], v[132:135], v[144:147], v[80:95]
    v_mfma_f32_32x32x16_bf16 v[96:111], v[128:131], v[148:151], v[96:111]
    v_mfma_f32_32x32x16_bf16 v[112:127], v[132:135], v[148:151], v[112:127]
    s_waitcnt vmcnt(1) lgkmcnt(0)
    s_barrier
    ds_read_b64_tr_b16 v[144:145], v20 offset:0
    ds_read_b64_tr_b16 v[146:147], v20 offset:512
    ds_read_b64_tr_b16 v[148:149], v20 offset:8192
    ds_read_b64_tr_b16 v[150:151], v20 offset:8704
    ds_read_b128 v[128:131], v16 offset:0
    ds_read_b128 v[132:135], v16 offset:4096
    v_mfma_f32_32x32x16_bf16 v[64:79], v[136:139], v[152:155], v[64:79]
    v_mfma_f32_32x32x16_bf16 v[80:95], v[140:143], v[152:155], v[80:95]
    v_mfma_f32_32x32x16_bf16 v[96:111], v[136:139], v[156:159], v[96:111]
    v_mfma_f32_32x32x16_bf16 v[112:127], v[140:143], v[156:159], v[112:127]
    ds_read_b64_tr_b16 v[152:153], v20 offset:2048
    ds_read_b64_tr_b16 v[154:155], v20 offset:2560
    ds_read_b64_tr_b16 v[156:157], v20 offset:10240
    ds_read_b64_tr_b16 v[158:159], v20 offset:10752
    ds_read_b128 v[136:139], v17 offset:0
    ds_read_b128 v[140:143], v17 offset:4096
    s_waitcnt lgkmcnt(6)
    v_mfma_f32_32x32x16_bf16 v[64:79], v[128:131], v[144:147], v[64:79]
    v_mfma_f32_32x32x16_bf16 v[80:95], v[132:135], v[144:147], v[80:95]
    v_mfma_f32_32x32x16_bf16 v[96:111], v[128:131], v[148:151], v[96:111]
    v_mfma_f32_32x32x16_bf16 v[112:127], v[132:135], v[148:151], v[112:127]
    ds_read_b64_tr_b16 v[144:145], v20 offset:4096
    ds_read_b64_tr_b16 v[146:147], v20 offset:4608
    ds_read_b64_tr_b16 v[148:149], v20 offset:12288
    ds_read_b64_tr_b16 v[150:151], v20 offset:12800
    ds_read_b128 v[128:131], v18 offset:0
    ds_read_b128 v[132:135], v18 offset:4096
    s_waitcnt lgkmcnt(6)
    v_mfma_f32_32x32x16_bf16 v[64:79], v[136:139], v[152:155], v[64:79]
    v_mfma_f32_32x32x16_bf16 v[80:95], v[140:143], v[152:155], v[80:95]
    v_mfma_f32_32x32x16_bf16 v[96:111], v[136:139], v[156:159], v[96:111]
    v_mfma_f32_32x32x16_bf16 v[112:127], v[140:143], v[156:159], v[112:127]
    ds_read_b64_tr_b16 v[152:153], v20 offset:6144
    ds_read_b64_tr_b16 v[154:155], v20 offset:6656
    ds_read_b64_tr_b16 v[156:157], v20 offset:14336
    ds_read_b64_tr_b16 v[158:159], v20 offset:14848
    ds_read_b128 v[136:139], v19 offset:0
    ds_read_b128 v[140:143], v19 offset:4096
    s_waitcnt lgkmcnt(6)
    v_mfma_f32_32x32x16_bf16 v[64:79], v[128:131], v[144:147], v[64:79]
    v_mfma_f32_32x32x16_bf16 v[80:95], v[132:135], v[144:147], v[80:95]
    v_mfma_f32_32x32x16_bf16 v[96:111], v[128:131], v[148:151], v[96:111]
    v_mfma_f32_32x32x16_bf16 v[112:127], v[132:135], v[148:151], v[112:127]
    s_waitcnt lgkmcnt(0)
    s_barrier
    v_mfma_f32_32x32x16_bf16 v[64:79], v[136:139], v[152:155], v[64:79]
    v_mfma_f32_32x32x16_bf16 v[80:95], v[140:143], v[152:155], v[80:95]
    v_mfma_f32_32x32x16_bf16 v[96:111], v[136:139], v[156:159], v[96:111]
    v_mfma_f32_32x32x16_bf16 v[112:127], v[140:143], v[156:159], v[112:127]
    s_setprio 3
    s_nop 7
    v_mul_f32 v36, s64, v64
    v_mul_f32 v37, s64, v65
    v_exp_f32_e64 v36, v36 clamp
    v_exp_f32_e64 v37, v37 clamp
    v_max_f32 v64, 0x358637bd, v64
    v_max_f32 v65, 0x358637bd, v65
    v_add_f32 v64, v64, v36
    v_add_f32 v65, v65, v37
    v_cvt_pk_bf16_f32 v128, v64, v65
    v_mul_f32 v38, s64, v66
    v_mul_f32 v39, s64, v67
    v_exp_f32_e64 v38, v38 clamp
    v_exp_f32_e64 v39, v39 clamp
    v_max_f32 v66, 0x358637bd, v66
    v_max_f32 v67, 0x358637bd, v67
    v_add_f32 v66, v66, v38
    v_add_f32 v67, v67, v39
    v_cvt_pk_bf16_f32 v129, v66, v67
    v_mul_f32 v40, s64, v68
    v_mul_f32 v41, s64, v69
    v_exp_f32_e64 v40, v40 clamp
    v_exp_f32_e64 v41, v41 clamp
    v_max_f32 v68, 0x358637bd, v68
    v_max_f32 v69, 0x358637bd, v69
    v_add_f32 v68, v68, v40
    v_add_f32 v69, v69, v41
    v_cvt_pk_bf16_f32 v130, v68, v69
    v_mul_f32 v42, s64, v70
    v_mul_f32 v43, s64, v71
    v_exp_f32_e64 v42, v42 clamp
    v_exp_f32_e64 v43, v43 clamp
    v_max_f32 v70, 0x358637bd, v70
    v_max_f32 v71, 0x358637bd, v71
    v_add_f32 v70, v70, v42
    v_add_f32 v71, v71, v43
    v_cvt_pk_bf16_f32 v131, v70, v71
    v_mul_f32 v36, s64, v72
    v_mul_f32 v37, s64, v73
    v_exp_f32_e64 v36, v36 clamp
    v_exp_f32_e64 v37, v37 clamp
    v_max_f32 v72, 0x358637bd, v72
    v_max_f32 v73, 0x358637bd, v73
    v_add_f32 v72, v72, v36
    v_add_f32 v73, v73, v37
    v_cvt_pk_bf16_f32 v132, v72, v73
    v_mul_f32 v38, s64, v74
    v_mul_f32 v39, s64, v75
    v_exp_f32_e64 v38, v38 clamp
    v_exp_f32_e64 v39, v39 clamp
    v_max_f32 v74, 0x358637bd, v74
    v_max_f32 v75, 0x358637bd, v75
    v_add_f32 v74, v74, v38
    v_add_f32 v75, v75, v39
    v_cvt_pk_bf16_f32 v133, v74, v75
    v_mul_f32 v40, s64, v76
    v_mul_f32 v41, s64, v77
    v_exp_f32_e64 v40, v40 clamp
    v_exp_f32_e64 v41, v41 clamp
    v_max_f32 v76, 0x358637bd, v76
    v_max_f32 v77, 0x358637bd, v77
    v_add_f32 v76, v76, v40
    v_add_f32 v77, v77, v41
    v_cvt_pk_bf16_f32 v134, v76, v77
    v_mul_f32 v42, s64, v78
    v_mul_f32 v43, s64, v79
    v_exp_f32_e64 v42, v42 clamp
    v_exp_f32_e64 v43, v43 clamp
    v_max_f32 v78, 0x358637bd, v78
    v_max_f32 v79, 0x358637bd, v79
    v_add_f32 v78, v78, v42
    v_add_f32 v79, v79, v43
    v_cvt_pk_bf16_f32 v135, v78, v79
    v_cvt_pk_bf16_f32 v144, v96, v97
    v_cvt_pk_bf16_f32 v145, v98, v99
    v_cvt_pk_bf16_f32 v146, v100, v101
    v_cvt_pk_bf16_f32 v147, v102, v103
    v_cvt_pk_bf16_f32 v148, v104, v105
    v_cvt_pk_bf16_f32 v149, v106, v107
    v_cvt_pk_bf16_f32 v150, v108, v109
    v_cvt_pk_bf16_f32 v151, v110, v111
    v_cvt_pk_bf16_f32 v152, v112, v113
    v_cvt_pk_bf16_f32 v153, v114, v115
    v_cvt_pk_bf16_f32 v154, v116, v117
    v_cvt_pk_bf16_f32 v155, v118, v119
    v_cvt_pk_bf16_f32 v156, v120, v121
    v_cvt_pk_bf16_f32 v157, v122, v123
    v_cvt_pk_bf16_f32 v158, v124, v125
    v_cvt_pk_bf16_f32 v159, v126, v127
    s_mov_b32 exec_lo, 268435456
    s_mov_b32 exec_hi, 268435456
    v_mov_b32 v144, 0x3f803f80
    v_mov_b32 v145, 0x3f803f80
    v_mov_b32 v146, 0x3f803f80
    v_mov_b32 v147, 0x3f803f80
    v_mov_b32 v148, 0x3f803f80
    v_mov_b32 v149, 0x3f803f80
    v_mov_b32 v150, 0x3f803f80
    v_mov_b32 v151, 0x3f803f80
    v_mov_b32 v152, 0x3f803f80
    v_mov_b32 v153, 0x3f803f80
    v_mov_b32 v154, 0x3f803f80
    v_mov_b32 v155, 0x3f803f80
    v_mov_b32 v156, 0x3f803f80
    v_mov_b32 v157, 0x3f803f80
    v_mov_b32 v158, 0x3f803f80
    v_mov_b32 v159, 0x3f803f80
    s_mov_b64 exec, -1
    v_mfma_f32_32x32x16_bf16 v[48:63], v[128:131], v[144:147], 0
    v_mfma_f32_32x32x16_bf16 v[48:63], v[132:135], v[148:151], v[48:63]
    v_mul_f32 v36, s64, v80
    v_mul_f32 v37, s64, v81
    v_exp_f32_e64 v36, v36 clamp
    v_exp_f32_e64 v37, v37 clamp
    v_max_f32 v80, 0x358637bd, v80
    v_max_f32 v81, 0x358637bd, v81
    v_add_f32 v80, v80, v36
    v_add_f32 v81, v81, v37
    v_cvt_pk_bf16_f32 v136, v80, v81
    v_mul_f32 v38, s64, v82
    v_mul_f32 v39, s64, v83
    v_exp_f32_e64 v38, v38 clamp
    v_exp_f32_e64 v39, v39 clamp
    v_max_f32 v82, 0x358637bd, v82
    v_max_f32 v83, 0x358637bd, v83
    v_add_f32 v82, v82, v38
    v_add_f32 v83, v83, v39
    v_cvt_pk_bf16_f32 v137, v82, v83
    v_mul_f32 v40, s64, v84
    v_mul_f32 v41, s64, v85
    v_exp_f32_e64 v40, v40 clamp
    v_exp_f32_e64 v41, v41 clamp
    v_max_f32 v84, 0x358637bd, v84
    v_max_f32 v85, 0x358637bd, v85
    v_add_f32 v84, v84, v40
    v_add_f32 v85, v85, v41
    v_cvt_pk_bf16_f32 v138, v84, v85
    v_mul_f32 v42, s64, v86
    v_mul_f32 v43, s64, v87
    v_exp_f32_e64 v42, v42 clamp
    v_exp_f32_e64 v43, v43 clamp
    v_max_f32 v86, 0x358637bd, v86
    v_max_f32 v87, 0x358637bd, v87
    v_add_f32 v86, v86, v42
    v_add_f32 v87, v87, v43
    v_cvt_pk_bf16_f32 v139, v86, v87
    v_mul_f32 v36, s64, v88
    v_mul_f32 v37, s64, v89
    v_exp_f32_e64 v36, v36 clamp
    v_exp_f32_e64 v37, v37 clamp
    v_max_f32 v88, 0x358637bd, v88
    v_max_f32 v89, 0x358637bd, v89
    v_add_f32 v88, v88, v36
    v_add_f32 v89, v89, v37
    v_cvt_pk_bf16_f32 v140, v88, v89
    v_mul_f32 v38, s64, v90
    v_mul_f32 v39, s64, v91
    v_exp_f32_e64 v38, v38 clamp
    v_exp_f32_e64 v39, v39 clamp
    v_max_f32 v90, 0x358637bd, v90
    v_max_f32 v91, 0x358637bd, v91
    v_add_f32 v90, v90, v38
    v_add_f32 v91, v91, v39
    v_cvt_pk_bf16_f32 v141, v90, v91
    v_mul_f32 v40, s64, v92
    v_mul_f32 v41, s64, v93
    v_exp_f32_e64 v40, v40 clamp
    v_exp_f32_e64 v41, v41 clamp
    v_max_f32 v92, 0x358637bd, v92
    v_max_f32 v93, 0x358637bd, v93
    v_add_f32 v92, v92, v40
    v_add_f32 v93, v93, v41
    v_cvt_pk_bf16_f32 v142, v92, v93
    v_mul_f32 v42, s64, v94
    v_mul_f32 v43, s64, v95
    v_exp_f32_e64 v42, v42 clamp
    v_exp_f32_e64 v43, v43 clamp
    v_max_f32 v94, 0x358637bd, v94
    v_max_f32 v95, 0x358637bd, v95
    v_add_f32 v94, v94, v42
    v_add_f32 v95, v95, v43
    v_cvt_pk_bf16_f32 v143, v94, v95
    v_mfma_f32_32x32x16_bf16 v[48:63], v[136:139], v[152:155], v[48:63]
    s_nop 0
    v_mfma_f32_32x32x16_bf16 v[48:63], v[140:143], v[156:159], v[48:63]
    s_waitcnt vmcnt(0)
    s_mov_b64 s[16:17], 0
Lp_4:
    v_cmp_ne_u64 vcc, s[46:47], v[26:27]
    s_cmp_eq_u64 vcc, 0
    s_cbranch_scc1 Lpo_5
    s_sub_u32 s15, s15, 1
    s_cbranch_scc1 L_end
    s_sub_u32 s18, vcc_lo, 1
    s_subb_u32 s19, vcc_hi, 0
    s_andn2_b64 s[18:19], vcc, s[18:19]
    s_cmp_eq_u64 vcc, s[16:17]
    s_mov_b64 s[16:17], vcc
    s_cselect_b64 exec, s[18:19], vcc
    s_sleep 1
    buffer_load_dwordx2 v[26:27], v6, s[48:51], 0 offen sc1
    s_mov_b64 exec, -1
    s_waitcnt vmcnt(0)
    s_branch Lp_4
Lpo_5:
    s_mov_b64 exec, -1
    s_nop 5
    ds_write_b128 v5, v[48:51] offset:0
    ds_write_b128 v5, v[52:55] offset:1024
    ds_write_b128 v5, v[56:59] offset:2048
    ds_write_b128 v5, v[60:63] offset:3072
    s_waitcnt lgkmcnt(0)
    s_barrier
    ds_read2st64_b32 v[64:65], v28 offset0:0 offset1:160
    ds_read2st64_b32 v[66:67], v29 offset0:0 offset1:160
    ds_read2st64_b32 v[68:69], v30 offset0:0 offset1:160
    ds_read2st64_b32 v[70:71], v31 offset0:0 offset1:160
    ds_read2st64_b32 v[72:73], v32 offset0:0 offset1:160
    ds_read2st64_b32 v[74:75], v33 offset0:0 offset1:160
    ds_read2st64_b32 v[76:77], v34 offset0:0 offset1:160
    ds_read2st64_b32 v[78:79], v35 offset0:0 offset1:160
    s_waitcnt lgkmcnt(7)
    v_add_f32 v64, v64, v65
    buffer_atomic_add_f32 v64, v28, s[48:51], s81 offen sc1
    s_waitcnt lgkmcnt(6)
    v_add_f32 v66, v66, v67
    buffer_atomic_add_f32 v66, v29, s[48:51], s81 offen sc1
    s_waitcnt lgkmcnt(5)
    v_add_f32 v68, v68, v69
    buffer_atomic_add_f32 v68, v30, s[48:51], s81 offen sc1
    s_waitcnt lgkmcnt(4)
    v_add_f32 v70, v70, v71
    buffer_atomic_add_f32 v70, v31, s[48:51], s81 offen sc1
    s_waitcnt lgkmcnt(3)
    v_add_f32 v72, v72, v73
    buffer_atomic_add_f32 v72, v32, s[48:51], s81 offen sc1
    s_waitcnt lgkmcnt(2)
    v_add_f32 v74, v74, v75
    buffer_atomic_add_f32 v74, v33, s[48:51], s81 offen sc1
    s_waitcnt lgkmcnt(1)
    v_add_f32 v76, v76, v77
    buffer_atomic_add_f32 v76, v34, s[48:51], s81 offen sc1
    s_waitcnt lgkmcnt(0)
    v_add_f32 v78, v78, v79
    buffer_atomic_add_f32 v78, v35, s[48:51], s81 offen sc1
    buffer_load_dwordx2 v[26:27], v22, s[48:51], 0 offen sc1
    s_cmp_ge_u32 s2, 224
    s_cbranch_scc1 L_kvw
    s_mov_b32 s56, s38
    s_mov_b32 s57, s39
    s_mov_b32 s58, 401408
    s_mov_b32 s59, 0x20000
    s_mul_i32 s68, s66, 20480
    s_mov_b32 s67, 0
    s_add_u32 m0, s68, 0
    s_nop 0
    buffer_load_dwordx4 v21, s[56:59], s67 offen lds
    s_add_u32 m0, s68, 1024
    s_add_u32 s67, s67, 7168
    buffer_load_dwordx4 v21, s[56:59], s67 offen lds
    s_add_u32 m0, s68, 2048
    s_add_u32 s67, s67, 7168
    buffer_load_dwordx4 v21, s[56:59], s67 offen lds
    s_add_u32 m0, s68, 3072
    s_add_u32 s67, s67, 7168
    buffer_load_dwordx4 v21, s[56:59], s67 offen lds
    s_add_u32 m0, s68, 4096
    s_add_u32 s67, s67, 7168
    buffer_load_dwordx4 v21, s[56:59], s67 offen lds
    s_add_u32 m0, s68, 5120
    s_add_u32 s67, s67, 7168
    buffer_load_dwordx4 v21, s[56:59], s67 offen lds
    s_waitcnt vmcnt(7)
L_kvw:
    s_cbranch_scc0 L_kvw2
    s_waitcnt vmcnt(1)
L_kvw2:
    s_barrier
    s_cmp_lg_u32 s66, 0
    s_cbranch_scc1 L_kvf
    s_mov_b64 exec, 1
    buffer_store_dwordx2 v[46:47], off, s[48:51], s75 sc1
    s_mov_b64 exec, -1
L_kvf:
    s_cmp_ge_u32 s2, 224
    s_cbranch_scc1 L_kvend
    s_add_u32 m0, s68, 6144
    s_add_u32 s67, s67, 7168
    buffer_load_dwordx4 v21, s[56:59], s67 offen lds
    s_add_u32 m0, s68, 7168
    s_add_u32 s67, s67, 7168
    buffer_load_dwordx4 v21, s[56:59], s67 offen lds
    s_add_u32 m0, s68, 8192
    s_add_u32 s67, s67, 7168
    buffer_load_dwordx4 v21, s[56:59], s67 offen lds
    s_add_u32 m0, s68, 9216
    s_add_u32 s67, s67, 7168
    buffer_load_dwordx4 v21, s[56:59], s67 offen lds
    s_add_u32 m0, s68, 10240
    s_add_u32 s67, s67, 7168
    buffer_load_dwordx4 v21, s[56:59], s67 offen lds
    s_add_u32 m0, s68, 11264
    s_add_u32 s67, s67, 7168
    buffer_load_dwordx4 v21, s[56:59], s67 offen lds
    s_add_u32 m0, s68, 12288
    s_add_u32 s67, s67, 7168
    buffer_load_dwordx4 v21, s[56:59], s67 offen lds
    s_add_u32 m0, s68, 13312
    s_add_u32 s67, s67, 7168
    buffer_load_dwordx4 v21, s[56:59], s67 offen lds
    s_add_u32 m0, s68, 14336
    s_add_u32 s67, s67, 7168
    buffer_load_dwordx4 v21, s[56:59], s67 offen lds
    s_waitcnt vmcnt(9)
    s_branch L_fin3
L_GQ:
    buffer_load_dwordx4 a[0:3], v8, s[52:55], s76 offen offset:0
    buffer_load_dwordx4 a[4:7], v9, s[52:55], s76 offen offset:1024
    buffer_load_dwordx4 a[8:11], v10, s[52:55], s76 offen offset:2048
    buffer_load_dwordx4 a[12:15], v11, s[52:55], s76 offen offset:3072
    s_add_u32 s76, s76, 128
    s_cmp_eq_u32 s76, 896
    s_cselect_b32 s76, 0, s76
    buffer_load_dwordx4 v[160:163], v12, s[56:59], s77 offen offset:0
    buffer_load_dwordx4 v[164:167], v13, s[56:59], s77 offen offset:1024
    s_add_u32 s77, s77, 172032
    s_cmp_eq_u32 s77, 1204224
    s_cselect_b32 s77, 0, s77
    buffer_load_dwordx4 a[16:19], v8, s[52:55], s76 offen offset:0
    buffer_load_dwordx4 a[20:23], v9, s[52:55], s76 offen offset:1024
    buffer_load_dwordx4 a[24:27], v10, s[52:55], s76 offen offset:2048
    buffer_load_dwordx4 a[28:31], v11, s[52:55], s76 offen offset:3072
    s_add_u32 s76, s76, 128
    s_cmp_eq_u32 s76, 896
    s_cselect_b32 s76, 0, s76
    buffer_load_dwordx4 v[168:171], v12, s[56:59], s77 offen offset:0
    buffer_load_dwordx4 v[172:175], v13, s[56:59], s77 offen offset:1024
    s_add_u32 s77, s77, 172032
    s_cmp_eq_u32 s77, 1204224
    s_cselect_b32 s77, 0, s77
    v_and_b32 v42, 31, v2
    v_lshrrev_b32 v40, 5, v2
    v_bfe_u32 v41, v2, 1, 3
    v_xor_b32 v41, v41, v40
    v_lshlrev_b32 v41, 4, v41
    v_lshl_add_u32 v41, v42, 7, v41
    s_lshr_b32 s67, s66, 1
    s_lshl_b32 s67, s67, 13
    v_add_u32 v16, s67, v41
    v_xor_b32 v17, 32, v16
    v_xor_b32 v18, 64, v16
    v_xor_b32 v19, 96, v16
    v_bfe_u32 v41, v2, 2, 2
    v_lshl_add_u32 v41, v40, 3, v41
    v_lshlrev_b32 v41, 7, v41
    v_and_b32 v45, 3, v2
    v_lshlrev_b32 v46, 3, v45
    v_bfe_u32 v47, v2, 4, 1
    v_lshl_add_u32 v46, v47, 5, v46
    s_and_b32 s67, s66, 1
    s_mul_i32 s67, s67, 56
    v_add_u32 v46, s67, v46
    v_bfe_u32 v47, v2, 3, 1
    v_lshlrev_b32 v47, 6, v47
    v_xor_b32 v46, v46, v47
    v_add_u32 v41, v41, v46
    v_add_u32 v20, 49152, v41
    s_and_b32 s67, s2, 31
    s_lshl_b32 s67, s67, 4
    s_lshl_b32 s68, s66, 2
    s_add_u32 s67, s67, s68
    s_lshl_b32 s67, s67, 7
    s_add_u32 s67, s67, 2392064
    v_lshlrev_b32 v45, 7, v45
    v_add_u32 v22, s67, v45
    s_lshl_b32 s67, s66, 12
    s_add_u32 s67, s67, 2457600
    v_lshlrev_b32 v23, 7, v42
    v_add_u32 v23, s67, v23
    v_lshlrev_b32 v44, 4, v44
    s_mul_i32 s67, s66, 100352
    s_lshr_b32 s68, s2, 5
    s_lshl_b32 s68, s68, 7
    s_add_u32 s67, s67, s68
    v_add3_u32 v21, v44, v43, s67
    v_add_u32 v24, s78, v3
    v_add_u32 v25, s79, v3
    s_mov_b32 s64, 1069066811
    s_mov_b32 s65, 1069066811
    s_mov_b32 s48, s44
    s_mov_b32 s49, s45
    s_mov_b32 s50, 7340032
    s_mov_b32 s51, 0x20000
    s_mov_b32 s60, s40
    s_mov_b32 s61, s41
    s_mov_b32 s62, 3670016
    s_mov_b32 s63, 0x20000
    s_memrealtime s[12:13]
    s_lshl_b32 s70, s72, 1
    s_lshr_b32 s68, s66, 1
    s_add_u32 s70, s70, s68
    s_lshl_b32 s70, s70, 4
    s_lshl_b32 s68, s73, 1
    s_add_u32 s68, s68, s70
    s_and_b32 s69, s66, 1
    s_add_u32 s68, s68, s69
    s_lshl_b32 s75, s68, 7
    s_add_u32 s75, s75, 2392064
    s_add_u32 s68, s68, s70
    s_lshl_b32 s81, s68, 11
    s_add_u32 s74, s81, 32768
    v_mov_b32 v64, 0x358637bd
    v_mov_b32 v65, 0x358637bd
    v_mov_b32 v66, 0x358637bd
    v_mov_b32 v67, 0x358637bd
    v_mov_b32 v68, 0x358637bd
    v_mov_b32 v69, 0x358637bd
    v_mov_b32 v70, 0x358637bd
    v_mov_b32 v71, 0x358637bd
    v_mov_b32 v72, 0x358637bd
    v_mov_b32 v73, 0x358637bd
    v_mov_b32 v74, 0x358637bd
    v_mov_b32 v75, 0x358637bd
    v_mov_b32 v76, 0x358637bd
    v_mov_b32 v77, 0x358637bd
    v_mov_b32 v78, 0x358637bd
    v_mov_b32 v79, 0x358637bd
    v_mov_b32 v80, 0x358637bd
    v_mov_b32 v81, 0x358637bd
    v_mov_b32 v82, 0x358637bd
    v_mov_b32 v83, 0x358637bd
    v_mov_b32 v84, 0x358637bd
    v_mov_b32 v85, 0x358637bd
    v_mov_b32 v86, 0x358637bd
    v_mov_b32 v87, 0x358637bd
    v_mov_b32 v88, 0x358637bd
    v_mov_b32 v89, 0x358637bd
    v_mov_b32 v90, 0x358637bd
    v_mov_b32 v91, 0x358637bd
    v_mov_b32 v92, 0x358637bd
    v_mov_b32 v93, 0x358637bd
    v_mov_b32 v94, 0x358637bd
    v_mov_b32 v95, 0x358637bd
    s_waitcnt vmcnt(8)
    ds_write_b128 v24, a[0:3] offset:0
    ds_write_b128 v24, a[4:7] offset:1024
    ds_write_b128 v24, a[8:11] offset:2048
    ds_write_b128 v24, a[12:15] offset:3072
    s_waitcnt vmcnt(6)
    ds_write_b128 v25, v[160:163] offset:0
    ds_write_b128 v25, v[164:167] offset:1024
    buffer_load_dwordx4 a[32:35], v8, s[52:55], s76 offen offset:0
    buffer_load_dwordx4 a[36:39], v9, s[52:55], s76 offen offset:1024
    buffer_load_dwordx4 a[40:43], v10, s[52:55], s76 offen offset:2048
    buffer_load_dwordx4 a[44:47], v11, s[52:55], s76 offen offset:3072
    s_add_u32 s76, s76, 128
    s_cmp_eq_u32 s76, 896
    s_cselect_b32 s76, 0, s76
    buffer_load_dwordx4 v[176:179], v12, s[56:59], s77 offen offset:0
    buffer_load_dwordx4 v[180:183], v13, s[56:59], s77 offen offset:1024
    s_add_u32 s77, s77, 172032
    s_cmp_eq_u32 s77, 1204224
    s_cselect_b32 s77, 0, s77
    s_waitcnt lgkmcnt(0)
    s_barrier
    ds_read_b64_tr_b16 v[144:145], v20 offset:0
    ds_read_b64_tr_b16 v[146:147], v20 offset:512
    ds_read_b128 v[128:131], v16 offset:0
    ds_read_b128 v[132:135], v16 offset:4096
    ds_read_b64_tr_b16 v[152:153], v20 offset:2048
    ds_read_b64_tr_b16 v[154:155], v20 offset:2560
    ds_read_b128 v[136:139], v17 offset:0
    ds_read_b128 v[140:143], v17 offset:4096
    s_waitcnt lgkmcnt(4)
    v_mfma_f32_32x32x16_bf16 v[64:79], v[144:147], v[128:131], v[64:79]
    s_waitcnt vmcnt(8)
    ds_write_b128 v24, a[16:19] offset:16384
    ds_write_b128 v24, a[20:23] offset:17408
    v_mfma_f32_32x32x16_bf16 v[80:95], v[144:147], v[132:135], v[80:95]
    ds_write_b128 v24, a[24:27] offset:18432
    ds_read_b64_tr_b16 v[144:145], v20 offset:4096
    ds_read_b64_tr_b16 v[146:147], v20 offset:4608
    ds_read_b128 v[128:131], v18 offset:0
    ds_read_b128 v[132:135], v18 offset:4096
    s_waitcnt lgkmcnt(7)
    v_mfma_f32_32x32x16_bf16 v[64:79], v[152:155], v[136:139], v[64:79]
    ds_write_b128 v24, a[28:31] offset:19456
    s_waitcnt vmcnt(6)
    ds_write_b128 v25, v[168:171] offset:8192
    ds_write_b128 v25, v[172:175] offset:9216
    v_mfma_f32_32x32x16_bf16 v[80:95], v[152:155], v[140:143], v[80:95]
    buffer_load_dwordx4 a[48:51], v8, s[52:55], s76 offen offset:0
    buffer_load_dwordx4 a[52:55], v9, s[52:55], s76 offen offset:1024
    buffer_load_dwordx4 a[56:59], v10, s[52:55], s76 offen offset:2048
    ds_read_b64_tr_b16 v[152:153], v20 offset:6144
    ds_read_b64_tr_b16 v[154:155], v20 offset:6656
    ds_read_b128 v[136:139], v19 offset:0
    ds_read_b128 v[140:143], v19 offset:4096
    s_waitcnt lgkmcnt(7)
    v_mfma_f32_32x32x16_bf16 v[64:79], v[144:147], v[128:131], v[64:79]
    buffer_load_dwordx4 a[60:63], v11, s[52:55], s76 offen offset:3072
    s_add_u32 s76, s76, 128
    s_cmp_eq_u32 s76, 896
    s_cselect_b32 s76, 0, s76
    buffer_load_dwordx4 v[96:99], v12, s[56:59], s77 offen offset:0
    v_mfma_f32_32x32x16_bf16 v[80:95], v[144:147], v[132:135], v[80:95]
    buffer_load_dwordx4 v[100:103], v13, s[56:59], s77 offen offset:1024
    s_add_u32 s77, s77, 172032
    s_cmp_eq_u32 s77, 1204224
    s_cselect_b32 s77, 0, s77
    s_waitcnt lgkmcnt(0)
    s_barrier
    ds_read_b64_tr_b16 v[144:145], v20 offset:8192
    ds_read_b64_tr_b16 v[146:147], v20 offset:8704
    ds_read_b128 v[128:131], v16 offset:16384
    ds_read_b128 v[132:135], v16 offset:20480
    v_mfma_f32_32x32x16_bf16 v[64:79], v[152:155], v[136:139], v[64:79]
    buffer_load_dwordx4 a[0:3], v8, s[52:55], s76 offen offset:0
    buffer_load_dwordx4 a[4:7], v9, s[52:55], s76 offen offset:1024
    buffer_load_dwordx4 a[8:11], v10, s[52:55], s76 offen offset:2048
    buffer_load_dwordx4 a[12:15], v11, s[52:55], s76 offen offset:3072
    s_add_u32 s76, s76, 128
    s_cmp_eq_u32 s76, 896
    s_cselect_b32 s76, 0, s76
    v_mfma_f32_32x32x16_bf16 v[80:95], v[152:155], v[140:143], v[80:95]
    buffer_load_dwordx4 v[160:163], v12, s[56:59], s77 offen offset:0
    buffer_load_dwordx4 v[164:167], v13, s[56:59], s77 offen offset:1024
    s_add_u32 s77, s77, 172032
    s_cmp_eq_u32 s77, 1204224
    s_cselect_b32 s77, 0, s77
    s_waitcnt vmcnt(14)
    ds_write_b128 v24, a[32:35] offset:32768
    ds_read_b64_tr_b16 v[152:153], v20 offset:10240
    ds_read_b64_tr_b16 v[154:155], v20 offset:10752
    ds_read_b128 v[136:139], v17 offset:16384
    ds_read_b128 v[140:143], v17 offset:20480
    s_waitcnt lgkmcnt(5)
    v_mfma_f32_32x32x16_bf16 v[64:79], v[144:147], v[128:131], v[64:79]
    ds_write_b128 v24, a[36:39] offset:33792
    ds_write_b128 v24, a[40:43] offset:34816
    v_mfma_f32_32x32x16_bf16 v[80:95], v[144:147], v[132:135], v[80:95]
    ds_write_b128 v24, a[44:47] offset:35840
    ds_read_b64_tr_b16 v[144:145], v20 offset:12288
    ds_read_b64_tr_b16 v[146:147], v20 offset:12800
    ds_read_b128 v[128:131], v18 offset:16384
    ds_read_b128 v[132:135], v18 offset:20480
    s_waitcnt lgkmcnt(7)
    v_mfma_f32_32x32x16_bf16 v[64:79], v[152:155], v[136:139], v[64:79]
    s_waitcnt vmcnt(12)
    ds_write_b128 v25, v[176:179] offset:16384
    ds_write_b128 v25, v[180:183] offset:17408
    v_mfma_f32_32x32x16_bf16 v[80:95], v[152:155], v[140:143], v[80:95]
    buffer_load_dwordx4 a[16:19], v8, s[52:55], s76 offen offset:0
    ds_read_b64_tr_b16 v[152:153], v20 offset:14336
    ds_read_b64_tr_b16 v[154:155], v20 offset:14848
    ds_read_b128 v[136:139], v19 offset:16384
    ds_read_b128 v[140:143], v19 offset:20480
    s_waitcnt lgkmcnt(6)
    v_mfma_f32_32x32x16_bf16 v[64:79], v[144:147], v[128:131], v[64:79]
    buffer_load_dwordx4 a[20:23], v9, s[52:55], s76 offen offset:1024
    v_mfma_f32_32x32x16_bf16 v[80:95], v[144:147], v[132:135], v[80:95]
    buffer_load_dwordx4 a[24:27], v10, s[52:55], s76 offen offset:2048
    s_waitcnt lgkmcnt(0)
    s_barrier
    ds_read_b64_tr_b16 v[144:145], v20 offset:16384
    ds_read_b64_tr_b16 v[146:147], v20 offset:16896
    ds_read_b128 v[128:131], v16 offset:32768
    ds_read_b128 v[132:135], v16 offset:36864
    v_mfma_f32_32x32x16_bf16 v[64:79], v[152:155], v[136:139], v[64:79]
    buffer_load_dwordx4 a[28:31], v11, s[52:55], s76 offen offset:3072
    s_add_u32 s76, s76, 128
    s_cmp_eq_u32 s76, 896
    s_cselect_b32 s76, 0, s76
    buffer_load_dwordx4 v[168:171], v12, s[56:59], s77 offen offset:0
    v_mfma_f32_32x32x16_bf16 v[80:95], v[152:155], v[140:143], v[80:95]
    buffer_load_dwordx4 v[172:175], v13, s[56:59], s77 offen offset:1024
    s_add_u32 s77, s77, 172032
    s_cmp_eq_u32 s77, 1204224
    s_cselect_b32 s77, 0, s77
    s_waitcnt vmcnt(14)
    ds_write_b128 v24, a[48:51] offset:0
    ds_read_b64_tr_b16 v[152:153], v20 offset:18432
    ds_read_b64_tr_b16 v[154:155], v20 offset:18944
    ds_read_b128 v[136:139], v17 offset:32768
    ds_read_b128 v[140:143], v17 offset:36864
    s_waitcnt lgkmcnt(5)
    v_mfma_f32_32x32x16_bf16 v[64:79], v[144:147], v[128:131], v[64:79]
    ds_write_b128 v24, a[52:55] offset:1024
    ds_write_b128 v24, a[56:59] offset:2048
    v_mfma_f32_32x32x16_bf16 v[80:95], v[144:147], v[132:135], v[80:95]
    ds_write_b128 v24, a[60:63] offset:3072
    ds_read_b64_tr_b16 v[144:145], v20 offset:20480
    ds_read_b64_tr_b16 v[146:147], v20 offset:20992
    ds_read_b128 v[128:131], v18 offset:32768
    ds_read_b128 v[132:135], v18 offset:36864
    s_waitcnt lgkmcnt(7)
    v_mfma_f32_32x32x16_bf16 v[64:79], v[152:155], v[136:139], v[64:79]
    s_waitcnt vmcnt(12)
    ds_write_b128 v25, v[96:99] offset:24576
    ds_write_b128 v25, v[100:103] offset:25600
    v_mfma_f32_32x32x16_bf16 v[80:95], v[152:155], v[140:143], v[80:95]
    buffer_load_dwordx4 a[32:35], v8, s[52:55], s76 offen offset:0
    ds_read_b64_tr_b16 v[152:153], v20 offset:22528
    ds_read_b64_tr_b16 v[154:155], v20 offset:23040
    ds_read_b128 v[136:139], v19 offset:32768
    ds_read_b128 v[140:143], v19 offset:36864
    s_waitcnt lgkmcnt(6)
    v_mfma_f32_32x32x16_bf16 v[64:79], v[144:147], v[128:131], v[64:79]
    buffer_load_dwordx4 a[36:39], v9, s[52:55], s76 offen offset:1024
    v_mfma_f32_32x32x16_bf16 v[80:95], v[144:147], v[132:135], v[80:95]
    buffer_load_dwordx4 a[40:43], v10, s[52:55], s76 offen offset:2048
    s_waitcnt lgkmcnt(0)
    s_barrier
    ds_read_b64_tr_b16 v[144:145], v20 offset:24576
    ds_read_b64_tr_b16 v[146:147], v20 offset:25088
    ds_read_b128 v[128:131], v16 offset:0
    ds_read_b128 v[132:135], v16 offset:4096
    v_mfma_f32_32x32x16_bf16 v[64:79], v[152:155], v[136:139], v[64:79]
    buffer_load_dwordx4 a[44:47], v11, s[52:55], s76 offen offset:3072
    s_add_u32 s76, s76, 128
    s_cmp_eq_u32 s76, 896
    s_cselect_b32 s76, 0, s76
    buffer_load_dwordx4 v[176:179], v12, s[56:59], s77 offen offset:0
    v_mfma_f32_32x32x16_bf16 v[80:95], v[152:155], v[140:143], v[80:95]
    buffer_load_dwordx4 v[180:183], v13, s[56:59], s77 offen offset:1024
    s_add_u32 s77, s77, 172032
    s_cmp_eq_u32 s77, 1204224
    s_cselect_b32 s77, 0, s77
    s_waitcnt vmcnt(14)
    ds_write_b128 v24, a[0:3] offset:16384
    ds_read_b64_tr_b16 v[152:153], v20 offset:26624
    ds_read_b64_tr_b16 v[154:155], v20 offset:27136
    ds_read_b128 v[136:139], v17 offset:0
    ds_read_b128 v[140:143], v17 offset:4096
    s_waitcnt lgkmcnt(5)
    v_mfma_f32_32x32x16_bf16 v[64:79], v[144:147], v[128:131], v[64:79]
    ds_write_b128 v24, a[4:7] offset:17408
    ds_write_b128 v24, a[8:11] offset:18432
    v_mfma_f32_32x32x16_bf16 v[80:95], v[144:147], v[132:135], v[80:95]
    ds_write_b128 v24, a[12:15] offset:19456
    ds_read_b64_tr_b16 v[144:145], v20 offset:28672
    ds_read_b64_tr_b16 v[146:147], v20 offset:29184
    ds_read_b128 v[128:131], v18 offset:0
    ds_read_b128 v[132:135], v18 offset:4096
    s_waitcnt lgkmcnt(7)
    v_mfma_f32_32x32x16_bf16 v[64:79], v[152:155], v[136:139], v[64:79]
    s_waitcnt vmcnt(12)
    ds_write_b128 v25, v[160:163] offset:0
    v_mfma_f32_32x32x16_bf16 v[80:95], v[152:155], v[140:143], v[80:95]
    ds_write_b128 v25, v[164:167] offset:1024
    ds_read_b64_tr_b16 v[152:153], v20 offset:30720
    ds_read_b64_tr_b16 v[154:155], v20 offset:31232
    ds_read_b128 v[136:139], v19 offset:0
    ds_read_b128 v[140:143], v19 offset:4096
    s_waitcnt lgkmcnt(6)
    v_mfma_f32_32x32x16_bf16 v[64:79], v[144:147], v[128:131], v[64:79]
    global_load_dwordx2 v[46:47], v4, s[42:43] sc1
    v_mfma_f32_32x32x16_bf16 v[80:95], v[144:147], v[132:135], v[80:95]
    s_waitcnt lgkmcnt(0)
    s_barrier
    ds_read_b64_tr_b16 v[144:145], v20 offset:0
    ds_read_b64_tr_b16 v[146:147], v20 offset:512
    ds_read_b128 v[128:131], v16 offset:16384
    ds_read_b128 v[132:135], v16 offset:20480
    v_mfma_f32_32x32x16_bf16 v[64:79], v[152:155], v[136:139], v[64:79]
    s_waitcnt vmcnt(9)
    ds_write_b128 v24, a[16:19] offset:32768
    v_mfma_f32_32x32x16_bf16 v[80:95], v[152:155], v[140:143], v[80:95]
    ds_read_b64_tr_b16 v[152:153], v20 offset:2048
    ds_read_b64_tr_b16 v[154:155], v20 offset:2560
    ds_read_b128 v[136:139], v17 offset:16384
    ds_read_b128 v[140:143], v17 offset:20480
    s_waitcnt lgkmcnt(5)
    v_mfma_f32_32x32x16_bf16 v[64:79], v[144:147], v[128:131], v[64:79]
    ds_write_b128 v24, a[20:23] offset:33792
    ds_write_b128 v24, a[24:27] offset:34816
    v_mfma_f32_32x32x16_bf16 v[80:95], v[144:147], v[132:135], v[80:95]
    ds_write_b128 v24, a[28:31] offset:35840
    ds_read_b64_tr_b16 v[144:145], v20 offset:4096
    ds_read_b64_tr_b16 v[146:147], v20 offset:4608
    ds_read_b128 v[128:131], v18 offset:16384
    ds_read_b128 v[132:135], v18 offset:20480
    s_waitcnt lgkmcnt(7)
    v_mfma_f32_32x32x16_bf16 v[64:79], v[152:155], v[136:139], v[64:79]
    s_waitcnt vmcnt(7)
    ds_write_b128 v25, v[168:171] offset:8192
    v_mfma_f32_32x32x16_bf16 v[80:95], v[152:155], v[140:143], v[80:95]
    ds_write_b128 v25, v[172:175] offset:9216
    ds_read_b64_tr_b16 v[152:153], v20 offset:6144
    ds_read_b64_tr_b16 v[154:155], v20 offset:6656
    ds_read_b128 v[136:139], v19 offset:16384
    ds_read_b128 v[140:143], v19 offset:20480
    s_waitcnt lgkmcnt(6)
    v_mfma_f32_32x32x16_bf16 v[64:79], v[144:147], v[128:131], v[64:79]
    v_mfma_f32_32x32x16_bf16 v[80:95], v[144:147], v[132:135], v[80:95]
    s_waitcnt lgkmcnt(0)
    s_barrier
    ds_read_b64_tr_b16 v[144:145], v20 offset:8192
    ds_read_b64_tr_b16 v[146:147], v20 offset:8704
    ds_read_b128 v[128:131], v16 offset:32768
    ds_read_b128 v[132:135], v16 offset:36864
    v_mfma_f32_32x32x16_bf16 v[64:79], v[152:155], v[136:139], v[64:79]
    s_waitcnt vmcnt(3)
    ds_write_b128 v24, a[32:35] offset:0
    v_mfma_f32_32x32x16_bf16 v[80:95], v[152:155], v[140:143], v[80:95]
    ds_read_b64_tr_b16 v[152:153], v20 offset:10240
    ds_read_b64_tr_b16 v[154:155], v20 offset:10752
    ds_read_b128 v[136:139], v17 offset:32768
    ds_read_b128 v[140:143], v17 offset:36864
    s_waitcnt lgkmcnt(5)
    v_mfma_f32_32x32x16_bf16 v[64:79], v[144:147], v[128:131], v[64:79]
    ds_write_b128 v24, a[36:39] offset:1024
    ds_write_b128 v24, a[40:43] offset:2048
    v_mfma_f32_32x32x16_bf16 v[80:95], v[144:147], v[132:135], v[80:95]
    ds_write_b128 v24, a[44:47] offset:3072
    ds_read_b64_tr_b16 v[144:145], v20 offset:12288
    ds_read_b64_tr_b16 v[146:147], v20 offset:12800
    ds_read_b128 v[128:131], v18 offset:32768
    ds_read_b128 v[132:135], v18 offset:36864
    s_waitcnt lgkmcnt(7)
    v_mfma_f32_32x32x16_bf16 v[64:79], v[152:155], v[136:139], v[64:79]
    s_waitcnt vmcnt(1)
    ds_write_b128 v25, v[176:179] offset:16384
    v_mfma_f32_32x32x16_bf16 v[80:95], v[152:155], v[140:143], v[80:95]
    ds_write_b128 v25, v[180:183] offset:17408
    ds_read_b64_tr_b16 v[152:153], v20 offset:14336
    ds_read_b64_tr_b16 v[154:155], v20 offset:14848
    ds_read_b128 v[136:139], v19 offset:32768
    ds_read_b128 v[140:143], v19 offset:36864
    s_waitcnt lgkmcnt(6)
    v_mfma_f32_32x32x16_bf16 v[64:79], v[144:147], v[128:131], v[64:79]
    v_mfma_f32_32x32x16_bf16 v[80:95], v[144:147], v[132:135], v[80:95]
    s_waitcnt lgkmcnt(0)
    s_barrier
    ds_read_b64_tr_b16 v[144:145], v20 offset:16384
    ds_read_b64_tr_b16 v[146:147], v20 offset:16896
    ds_read_b128 v[128:131], v16 offset:0
    ds_read_b128 v[132:135], v16 offset:4096
    v_mfma_f32_32x32x16_bf16 v[64:79], v[152:155], v[136:139], v[64:79]
    v_mfma_f32_32x32x16_bf16 v[80:95], v[152:155], v[140:143], v[80:95]
    ds_read_b64_tr_b16 v[152:153], v20 offset:18432
    ds_read_b64_tr_b16 v[154:155], v20 offset:18944
    ds_read_b128 v[136:139], v17 offset:0
    ds_read_b128 v[140:143], v17 offset:4096
    s_waitcnt lgkmcnt(4)
    v_mfma_f32_32x32x16_bf16 v[64:79], v[144:147], v[128:131], v[64:79]
    v_mfma_f32_32x32x16_bf16 v[80:95], v[144:147], v[132:135], v[80:95]
    ds_read_b64_tr_b16 v[144:145], v20 offset:20480
    ds_read_b64_tr_b16 v[146:147], v20 offset:20992
    ds_read_b128 v[128:131], v18 offset:0
    ds_read_b128 v[132:135], v18 offset:4096
    s_waitcnt lgkmcnt(4)
    v_mfma_f32_32x32x16_bf16 v[64:79], v[152:155], v[136:139], v[64:79]
    v_mfma_f32_32x32x16_bf16 v[80:95], v[152:155], v[140:143], v[80:95]
    ds_read_b64_tr_b16 v[152:153], v20 offset:22528
    ds_read_b64_tr_b16 v[154:155], v20 offset:23040
    ds_read_b128 v[136:139], v19 offset:0
    ds_read_b128 v[140:143], v19 offset:4096
    s_waitcnt lgkmcnt(4)
    v_mfma_f32_32x32x16_bf16 v[64:79], v[144:147], v[128:131], v[64:79]
    v_mfma_f32_32x32x16_bf16 v[80:95], v[144:147], v[132:135], v[80:95]
    s_waitcnt lgkmcnt(0)
    v_mfma_f32_32x32x16_bf16 v[64:79], v[152:155], v[136:139], v[64:79]
    v_mfma_f32_32x32x16_bf16 v[80:95], v[152:155], v[140:143], v[80:95]
    s_setprio 3
    s_nop 9
    v_mul_f32 v36, s64, v64
    v_mul_f32 v37, s64, v65
    v_exp_f32_e64 v36, v36 clamp
    v_exp_f32_e64 v37, v37 clamp
    v_max_f32 v64, 0x358637bd, v64
    v_max_f32 v65, 0x358637bd, v65
    v_add_f32 v64, v64, v36
    v_add_f32 v65, v65, v37
    v_cvt_pk_bf16_f32 v128, v64, v65
    v_mul_f32 v38, s64, v66
    v_mul_f32 v39, s64, v67
    v_exp_f32_e64 v38, v38 clamp
    v_exp_f32_e64 v39, v39 clamp
    v_max_f32 v66, 0x358637bd, v66
    v_max_f32 v67, 0x358637bd, v67
    v_add_f32 v66, v66, v38
    v_add_f32 v67, v67, v39
    v_cvt_pk_bf16_f32 v129, v66, v67
    v_mul_f32 v40, s64, v68
    v_mul_f32 v41, s64, v69
    v_exp_f32_e64 v40, v40 clamp
    v_exp_f32_e64 v41, v41 clamp
    v_max_f32 v68, 0x358637bd, v68
    v_max_f32 v69, 0x358637bd, v69
    v_add_f32 v68, v68, v40
    v_add_f32 v69, v69, v41
    v_cvt_pk_bf16_f32 v130, v68, v69
    v_mul_f32 v42, s64, v70
    v_mul_f32 v43, s64, v71
    v_exp_f32_e64 v42, v42 clamp
    v_exp_f32_e64 v43, v43 clamp
    v_max_f32 v70, 0x358637bd, v70
    v_max_f32 v71, 0x358637bd, v71
    v_add_f32 v70, v70, v42
    v_add_f32 v71, v71, v43
    v_cvt_pk_bf16_f32 v131, v70, v71
    v_mul_f32 v36, s64, v72
    v_mul_f32 v37, s64, v73
    v_exp_f32_e64 v36, v36 clamp
    v_exp_f32_e64 v37, v37 clamp
    v_max_f32 v72, 0x358637bd, v72
    v_max_f32 v73, 0x358637bd, v73
    v_add_f32 v72, v72, v36
    v_add_f32 v73, v73, v37
    v_cvt_pk_bf16_f32 v132, v72, v73
    v_mul_f32 v38, s64, v74
    v_mul_f32 v39, s64, v75
    v_exp_f32_e64 v38, v38 clamp
    v_exp_f32_e64 v39, v39 clamp
    v_max_f32 v74, 0x358637bd, v74
    v_max_f32 v75, 0x358637bd, v75
    v_add_f32 v74, v74, v38
    v_add_f32 v75, v75, v39
    v_cvt_pk_bf16_f32 v133, v74, v75
    v_mul_f32 v40, s64, v76
    v_mul_f32 v41, s64, v77
    v_exp_f32_e64 v40, v40 clamp
    v_exp_f32_e64 v41, v41 clamp
    v_max_f32 v76, 0x358637bd, v76
    v_max_f32 v77, 0x358637bd, v77
    v_add_f32 v76, v76, v40
    v_add_f32 v77, v77, v41
    v_cvt_pk_bf16_f32 v134, v76, v77
    v_mul_f32 v42, s64, v78
    v_mul_f32 v43, s64, v79
    v_exp_f32_e64 v42, v42 clamp
    v_exp_f32_e64 v43, v43 clamp
    v_max_f32 v78, 0x358637bd, v78
    v_max_f32 v79, 0x358637bd, v79
    v_add_f32 v78, v78, v42
    v_add_f32 v79, v79, v43
    v_cvt_pk_bf16_f32 v135, v78, v79
    buffer_store_dwordx4 v[128:131], v3, s[48:51], s81 offen offset:0 sc1
    buffer_store_dwordx4 v[132:135], v3, s[48:51], s81 offen offset:1024 sc1
    v_mul_f32 v36, s64, v80
    v_mul_f32 v37, s64, v81
    v_exp_f32_e64 v36, v36 clamp
    v_exp_f32_e64 v37, v37 clamp
    v_max_f32 v80, 0x358637bd, v80
    v_max_f32 v81, 0x358637bd, v81
    v_add_f32 v80, v80, v36
    v_add_f32 v81, v81, v37
    v_cvt_pk_bf16_f32 v136, v80, v81
    v_mul_f32 v38, s64, v82
    v_mul_f32 v39, s64, v83
    v_exp_f32_e64 v38, v38 clamp
    v_exp_f32_e64 v39, v39 clamp
    v_max_f32 v82, 0x358637bd, v82
    v_max_f32 v83, 0x358637bd, v83
    v_add_f32 v82, v82, v38
    v_add_f32 v83, v83, v39
    v_cvt_pk_bf16_f32 v137, v82, v83
    v_mul_f32 v40, s64, v84
    v_mul_f32 v41, s64, v85
    v_exp_f32_e64 v40, v40 clamp
    v_exp_f32_e64 v41, v41 clamp
    v_max_f32 v84, 0x358637bd, v84
    v_max_f32 v85, 0x358637bd, v85
    v_add_f32 v84, v84, v40
    v_add_f32 v85, v85, v41
    v_cvt_pk_bf16_f32 v138, v84, v85
    v_mul_f32 v42, s64, v86
    v_mul_f32 v43, s64, v87
    v_exp_f32_e64 v42, v42 clamp
    v_exp_f32_e64 v43, v43 clamp
    v_max_f32 v86, 0x358637bd, v86
    v_max_f32 v87, 0x358637bd, v87
    v_add_f32 v86, v86, v42
    v_add_f32 v87, v87, v43
    v_cvt_pk_bf16_f32 v139, v86, v87
    v_mul_f32 v36, s64, v88
    v_mul_f32 v37, s64, v89
    v_exp_f32_e64 v36, v36 clamp
    v_exp_f32_e64 v37, v37 clamp
    v_max_f32 v88, 0x358637bd, v88
    v_max_f32 v89, 0x358637bd, v89
    v_add_f32 v88, v88, v36
    v_add_f32 v89, v89, v37
    v_cvt_pk_bf16_f32 v140, v88, v89
    v_mul_f32 v38, s64, v90
    v_mul_f32 v39, s64, v91
    v_exp_f32_e64 v38, v38 clamp
    v_exp_f32_e64 v39, v39 clamp
    v_max_f32 v90, 0x358637bd, v90
    v_max_f32 v91, 0x358637bd, v91
    v_add_f32 v90, v90, v38
    v_add_f32 v91, v91, v39
    v_cvt_pk_bf16_f32 v141, v90, v91
    v_mul_f32 v40, s64, v92
    v_mul_f32 v41, s64, v93
    v_exp_f32_e64 v40, v40 clamp
    v_exp_f32_e64 v41, v41 clamp
    v_max_f32 v92, 0x358637bd, v92
    v_max_f32 v93, 0x358637bd, v93
    v_add_f32 v92, v92, v40
    v_add_f32 v93, v93, v41
    v_cvt_pk_bf16_f32 v142, v92, v93
    v_mul_f32 v42, s64, v94
    v_mul_f32 v43, s64, v95
    v_exp_f32_e64 v42, v42 clamp
    v_exp_f32_e64 v43, v43 clamp
    v_max_f32 v94, 0x358637bd, v94
    v_max_f32 v95, 0x358637bd, v95
    v_add_f32 v94, v94, v42
    v_add_f32 v95, v95, v43
    v_cvt_pk_bf16_f32 v143, v94, v95
    buffer_store_dwordx4 v[136:139], v3, s[48:51], s74 offen offset:0 sc1
    buffer_store_dwordx4 v[140:143], v3, s[48:51], s74 offen offset:1024 sc1
    s_waitcnt vmcnt(4)
    s_waitcnt lgkmcnt(0)
    s_mov_b32 s13, 200
Li_6:
    v_readfirstlane_b32 s46, v46
    v_readfirstlane_b32 s47, v47
    s_sub_u32 s3, s46, s12
    s_cmp_eq_u32 s46, 0
    s_cbranch_scc1 Lir_8
    s_cmp_gt_i32 s3, -900
    s_cbranch_scc1 Lio_7
    s_sub_u32 s13, s13, 1
    s_cbranch_scc1 Lio_7
Lir_8:
    s_sub_u32 s15, s15, 1
    s_cbranch_scc1 L_end
    s_sleep 1
    global_load_dwordx2 v[46:47], v4, s[42:43] sc1
    s_waitcnt vmcnt(0)
    s_branch Li_6
Lio_7:
    s_waitcnt vmcnt(0)
    s_mov_b64 exec, 1
    buffer_store_dwordx2 v[46:47], off, s[48:51], s75 sc1
    s_mov_b64 exec, -1
    s_cmp_ge_u32 s2, 224
    s_cbranch_scc1 L_kvend
    s_barrier
    buffer_load_dwordx2 v[26:27], v22, s[48:51], 0 offen sc1
    s_waitcnt vmcnt(0)
L_fin3:
    s_setprio 1
    v_mov_b32 v12, v23
    s_mov_b64 s[16:17], 0
Lp_9:
    v_cmp_ne_u64 vcc, s[46:47], v[26:27]
    s_cmp_eq_u64 vcc, 0
    s_cbranch_scc1 Lpo_10
    s_sub_u32 s15, s15, 1
    s_cbranch_scc1 L_end
    s_sub_u32 s18, vcc_lo, 1
    s_subb_u32 s19, vcc_hi, 0
    s_andn2_b64 s[18:19], vcc, s[18:19]
    s_cmp_eq_u64 vcc, s[16:17]
    s_mov_b64 s[16:17], vcc
    s_cselect_b64 exec, s[18:19], vcc
    s_sleep 1
    buffer_load_dwordx2 v[26:27], v22, s[48:51], 0 offen sc1
    s_mov_b64 exec, -1
    s_waitcnt vmcnt(0)
    s_branch Lp_9
Lpo_10:
    s_mov_b64 exec, -1
    s_and_b32 s67, s2, 31
    s_lshl_b32 s67, s67, 16
    s_lshl_b32 s68, s66, 13
    s_add_u32 s67, s67, s68
    s_add_u32 s68, s67, 32768
    s_add_u32 s69, s67, 4096
    s_add_u32 s70, s68, 4096
    buffer_load_dwordx4 a[0:3], v3, s[48:51], s67 offen offset:0 sc1
    buffer_load_dwordx4 a[4:7], v3, s[48:51], s67 offen offset:1024 sc1
    buffer_load_dwordx4 a[8:11], v3, s[48:51], s68 offen offset:0 sc1
    buffer_load_dwordx4 a[12:15], v3, s[48:51], s68 offen offset:1024 sc1
    buffer_load_dwordx4 a[16:19], v3, s[48:51], s67 offen offset:2048 sc1
    buffer_load_dwordx4 a[20:23], v3, s[48:51], s67 offen offset:3072 sc1
    buffer_load_dwordx4 a[24:27], v3, s[48:51], s68 offen offset:2048 sc1
    buffer_load_dwordx4 a[28:31], v3, s[48:51], s68 offen offset:3072 sc1
    buffer_load_dwordx4 a[32:35], v3, s[48:51], s69 offen offset:0 sc1
    buffer_load_dwordx4 a[36:39], v3, s[48:51], s69 offen offset:1024 sc1
    buffer_load_dwordx4 a[40:43], v3, s[48:51], s70 offen offset:0 sc1
    buffer_load_dwordx4 a[44:47], v3, s[48:51], s70 offen offset:1024 sc1
    buffer_load_dwordx4 a[48:51], v3, s[48:51], s69 offen offset:2048 sc1
    buffer_load_dwordx4 a[52:55], v3, s[48:51], s69 offen offset:3072 sc1
    buffer_load_dwordx4 a[56:59], v3, s[48:51], s70 offen offset:2048 sc1
    buffer_load_dwordx4 a[60:63], v3, s[48:51], s70 offen offset:3072 sc1
    s_cmp_lg_u32 s80, 0
    s_cbranch_scc1 L_havewo
    s_mov_b32 s56, s38
    s_mov_b32 s57, s39
    s_mov_b32 s58, 401408
    s_mov_b32 s59, 0x20000
    s_mul_i32 s68, s66, 20480
    s_mov_b32 s67, 0
    s_add_u32 m0, s68, 0
    s_nop 0
    buffer_load_dwordx4 v21, s[56:59], s67 offen lds
    s_add_u32 m0, s68, 1024
    s_add_u32 s67, s67, 7168
    buffer_load_dwordx4 v21, s[56:59], s67 offen lds
    s_add_u32 m0, s68, 2048
    s_add_u32 s67, s67, 7168
    buffer_load_dwordx4 v21, s[56:59], s67 offen lds
    s_add_u32 m0, s68, 3072
    s_add_u32 s67, s67, 7168
    buffer_load_dwordx4 v21, s[56:59], s67 offen lds
    s_add_u32 m0, s68, 4096
    s_add_u32 s67, s67, 7168
    buffer_load_dwordx4 v21, s[56:59], s67 offen lds
    s_add_u32 m0, s68, 5120
    s_add_u32 s67, s67, 7168
    buffer_load_dwordx4 v21, s[56:59], s67 offen lds
    s_add_u32 m0, s68, 6144
    s_add_u32 s67, s67, 7168
    buffer_load_dwordx4 v21, s[56:59], s67 offen lds
    s_add_u32 m0, s68, 7168
    s_add_u32 s67, s67, 7168
    buffer_load_dwordx4 v21, s[56:59], s67 offen lds
    s_add_u32 m0, s68, 8192
    s_add_u32 s67, s67, 7168
    buffer_load_dwordx4 v21, s[56:59], s67 offen lds
    s_add_u32 m0, s68, 9216
    s_add_u32 s67, s67, 7168
    buffer_load_dwordx4 v21, s[56:59], s67 offen lds
    s_add_u32 m0, s68, 10240
    s_add_u32 s67, s67, 7168
    buffer_load_dwordx4 v21, s[56:59], s67 offen lds
    s_add_u32 m0, s68, 11264
    s_add_u32 s67, s67, 7168
    buffer_load_dwordx4 v21, s[56:59], s67 offen lds
    s_add_u32 m0, s68, 12288
    s_add_u32 s67, s67, 7168
    buffer_load_dwordx4 v21, s[56:59], s67 offen lds
    s_add_u32 m0, s68, 13312
    s_add_u32 s67, s67, 7168
    buffer_load_dwordx4 v21, s[56:59], s67 offen lds
    s_add_u32 m0, s68, 14336
    s_add_u32 s67, s67, 7168
    buffer_load_dwordx4 v21, s[56:59], s67 offen lds
L_havewo:
    buffer_load_dwordx2 v[8:9], v12, s[48:51], 0 offen sc1
    s_lshl_b32 s67, s66, 14
    s_add_u32 s67, s67, 2097152
    s_mul_i32 s68, s66, 20480
    v_bfe_u32 v5, v2, 2, 2
    v_lshrrev_b32 v6, 5, v2
    v_lshl_add_u32 v5, v6, 2, v5
    v_lshlrev_b32 v5, 7, v5
    v_and_b32 v7, 1, v2
    v_lshl_add_u32 v5, v7, 5, v5
    v_bfe_u32 v7, v2, 4, 1
    v_lshl_add_u32 v5, v7, 4, v5
    v_bfe_u32 v7, v2, 1, 1
    v_lshl_add_u32 v5, v7, 3, v5
    v_bfe_u32 v7, v2, 3, 1
    v_lshl_add_u32 v5, v7, 6, v5
    v_xor_b32 v15, 64, v5
    v_add_u32 v5, s68, v5
    v_add_u32 v15, s68, v15
    s_mov_b32 s69, 0x358637bd
    s_mov_b32 s64, -1
    s_mov_b32 s65, 0
    v_and_b32 v13, 31, v2
    v_mul_u32_u24 v13, 272, v13
    v_lshl_add_u32 v13, v6, 6, v13
    v_add_u32 v13, s68, v13
    v_lshrrev_b32 v7, 3, v0
    v_and_b32 v14, 7, v0
    v_mul_u32_u24 v10, 272, v7
    v_lshl_add_u32 v10, v14, 5, v10
    v_mul_u32_u24 v11, 1792, v7
    v_lshl_add_u32 v11, v14, 4, v11
    s_and_b32 s70, s2, 31
    s_mul_i32 s70, s70, 114688
    s_lshr_b32 s71, s2, 5
    s_lshl_b32 s71, s71, 7
    s_add_u32 s70, s70, s71
    s_add_u32 s70, s70, 896
    s_add_u32 s71, s70, 57344
    v_mov_b32 v14, 0x7fff0000
    v_cndmask_b32 v14, v14, v3, s[64:65]
    s_waitcnt vmcnt(0)
    s_mov_b64 s[16:17], 0
Lp_11:
    v_cmp_ne_u64 vcc, s[46:47], v[8:9]
    s_cmp_eq_u64 vcc, 0
    s_cbranch_scc1 Lpo_12
    s_sub_u32 s15, s15, 1
    s_cbranch_scc1 L_end
    s_sub_u32 s18, vcc_lo, 1
    s_subb_u32 s19, vcc_hi, 0
    s_andn2_b64 s[18:19], vcc, s[18:19]
    s_cmp_eq_u64 vcc, s[16:17]
    s_mov_b64 s[16:17], vcc
    s_cselect_b64 exec, s[18:19], vcc
    s_sleep 1
    buffer_load_dwordx2 v[8:9], v12, s[48:51], 0 offen sc1
    s_mov_b64 exec, -1
    s_waitcnt vmcnt(0)
    s_branch Lp_11
Lpo_12:
    s_mov_b64 exec, -1
    buffer_load_dwordx4 v[16:19], v3, s[48:51], s67 offen offset:0 sc1
    buffer_load_dwordx4 v[20:23], v3, s[48:51], s67 offen offset:1024 sc1
    buffer_load_dwordx4 v[24:27], v3, s[48:51], s67 offen offset:2048 sc1
    buffer_load_dwordx4 v[28:31], v14, s[48:51], s67 offen offset:3072 sc1
    s_add_u32 s67, s67, 4096
    buffer_load_dwordx4 v[32:35], v3, s[48:51], s67 offen offset:0 sc1
    buffer_load_dwordx4 v[36:39], v3, s[48:51], s67 offen offset:1024 sc1
    buffer_load_dwordx4 v[40:43], v3, s[48:51], s67 offen offset:2048 sc1
    buffer_load_dwordx4 v[44:47], v14, s[48:51], s67 offen offset:3072 sc1
    s_add_u32 s67, s67, 4096
    buffer_load_dwordx4 v[144:147], v3, s[48:51], s67 offen offset:0 sc1
    buffer_load_dwordx4 v[148:151], v3, s[48:51], s67 offen offset:1024 sc1
    buffer_load_dwordx4 v[152:155], v3, s[48:51], s67 offen offset:2048 sc1
    buffer_load_dwordx4 v[156:159], v14, s[48:51], s67 offen offset:3072 sc1
    s_add_u32 s67, s67, 4096
    buffer_load_dwordx4 v[160:163], v3, s[48:51], s67 offen offset:0 sc1
    buffer_load_dwordx4 v[164:167], v3, s[48:51], s67 offen offset:1024 sc1
    buffer_load_dwordx4 v[168:171], v3, s[48:51], s67 offen offset:2048 sc1
    buffer_load_dwordx4 v[172:175], v14, s[48:51], s67 offen offset:3072 sc1
    ds_read_b64_tr_b16 v[176:177], v5 offset:0
    ds_read_b64_tr_b16 v[178:179], v5 offset:1024
    ds_read_b64_tr_b16 v[180:181], v15 offset:0
    ds_read_b64_tr_b16 v[182:183], v15 offset:1024
    ds_read_b64_tr_b16 v[184:185], v5 offset:2048
    ds_read_b64_tr_b16 v[186:187], v5 offset:3072
    ds_read_b64_tr_b16 v[188:189], v15 offset:2048
    ds_read_b64_tr_b16 v[190:191], v15 offset:3072
    v_add_u32 v12, 40960, v10
    s_waitcnt vmcnt(12)
    v_cvt_pk_bf16_f32 v128, v16, v17
    v_cvt_pk_bf16_f32 v129, v18, v19
    v_cvt_pk_bf16_f32 v130, v20, v21
    v_cvt_pk_bf16_f32 v131, v22, v23
    v_cvt_pk_bf16_f32 v132, v24, v25
    v_cvt_pk_bf16_f32 v133, v26, v27
    v_cvt_pk_bf16_f32 v134, v28, v29
    v_cvt_pk_bf16_f32 v135, v30, v31
    s_waitcnt vmcnt(8)
    v_cvt_pk_bf16_f32 v136, v32, v33
    v_cvt_pk_bf16_f32 v137, v34, v35
    v_cvt_pk_bf16_f32 v138, v36, v37
    v_cvt_pk_bf16_f32 v139, v38, v39
    v_cvt_pk_bf16_f32 v140, v40, v41
    v_cvt_pk_bf16_f32 v141, v42, v43
    v_cvt_pk_bf16_f32 v142, v44, v45
    v_cvt_pk_bf16_f32 v143, v46, v47
    v_mfma_f32_32x32x16_bf16 v[16:31], v[128:131], a[0:3], 0
    v_mfma_f32_32x32x16_bf16 v[16:31], v[132:135], a[4:7], v[16:31]
    v_mfma_f32_32x32x16_bf16 v[32:47], v[128:131], a[8:11], 0
    v_mfma_f32_32x32x16_bf16 v[32:47], v[132:135], a[12:15], v[32:47]
    s_nop 9
    v_mov_b32 v6, v28
    v_mov_b32 v8, v28
    s_nop 1
    v_permlane32_swap_b32 v6, v8
    v_add_f32 v8, s69, v8
    v_rcp_f32 v8, v8
    s_nop 0
    v_mul_f32 v16, v16, v8
    v_mul_f32 v17, v17, v8
    v_cvt_pk_bf16_f32 v48, v16, v17
    v_mul_f32 v18, v18, v8
    v_mul_f32 v19, v19, v8
    v_cvt_pk_bf16_f32 v49, v18, v19
    v_mul_f32 v20, v20, v8
    v_mul_f32 v21, v21, v8
    v_cvt_pk_bf16_f32 v50, v20, v21
    v_mul_f32 v22, v22, v8
    v_mul_f32 v23, v23, v8
    v_cvt_pk_bf16_f32 v51, v22, v23
    v_mul_f32 v24, v24, v8
    v_mul_f32 v25, v25, v8
    v_cvt_pk_bf16_f32 v52, v24, v25
    v_mul_f32 v26, v26, v8
    v_mul_f32 v27, v27, v8
    v_cvt_pk_bf16_f32 v53, v26, v27
    v_mul_f32 v28, v28, v8
    v_mul_f32 v29, v29, v8
    v_cvt_pk_bf16_f32 v54, v28, v29
    v_mul_f32 v30, v30, v8
    v_mul_f32 v31, v31, v8
    v_cvt_pk_bf16_f32 v55, v30, v31
    v_cndmask_b32 v54, 0, v54, s[64:65]
    v_cndmask_b32 v55, 0, v55, s[64:65]
    v_mfma_f32_32x32x16_bf16 v[16:31], v[136:139], a[16:19], 0
    v_mov_b32 v6, v44
    v_mov_b32 v8, v44
    s_nop 1
    v_permlane32_swap_b32 v6, v8
    v_add_f32 v8, s69, v8
    v_rcp_f32 v8, v8
    s_nop 0
    v_mul_f32 v32, v32, v8
    v_mfma_f32_32x32x16_bf16 v[16:31], v[140:143], a[20:23], v[16:31]
    v_mul_f32 v33, v33, v8
    v_cvt_pk_bf16_f32 v56, v32, v33
    v_mul_f32 v34, v34, v8
    v_mul_f32 v35, v35, v8
    v_cvt_pk_bf16_f32 v57, v34, v35
    s_waitcnt lgkmcnt(0)
    v_mfma_f32_32x32x16_bf16 v[64:79], v[176:179], v[48:51], 0
    v_mul_f32 v36, v36, v8
    v_mul_f32 v37, v37, v8
    v_cvt_pk_bf16_f32 v58, v36, v37
    v_mul_f32 v38, v38, v8
    v_mul_f32 v39, v39, v8
    v_mfma_f32_32x32x16_bf16 v[80:95], v[180:183], v[48:51], 0
    v_cvt_pk_bf16_f32 v59, v38, v39
    v_mul_f32 v40, v40, v8
    v_mul_f32 v41, v41, v8
    v_cvt_pk_bf16_f32 v60, v40, v41
    v_mul_f32 v42, v42, v8
    v_mfma_f32_32x32x16_bf16 v[64:79], v[184:187], v[52:55], v[64:79]
    v_mul_f32 v43, v43, v8
    v_cvt_pk_bf16_f32 v61, v42, v43
    v_mul_f32 v44, v44, v8
    v_mul_f32 v45, v45, v8
    v_cvt_pk_bf16_f32 v62, v44, v45
    v_mfma_f32_32x32x16_bf16 v[80:95], v[188:191], v[52:55], v[80:95]
    v_mul_f32 v46, v46, v8
    v_mul_f32 v47, v47, v8
    v_cvt_pk_bf16_f32 v63, v46, v47
    v_cndmask_b32 v62, 0, v62, s[64:65]
    v_cndmask_b32 v63, 0, v63, s[64:65]
    v_mfma_f32_32x32x16_bf16 v[32:47], v[136:139], a[24:27], 0
    v_mov_b32 v6, v28
    v_mov_b32 v8, v28
    s_nop 1
    v_permlane32_swap_b32 v6, v8
    v_add_f32 v8, s69, v8
    v_rcp_f32 v8, v8
    s_nop 0
    v_mul_f32 v16, v16, v8
    v_mfma_f32_32x32x16_bf16 v[32:47], v[140:143], a[28:31], v[32:47]
    v_mul_f32 v17, v17, v8
    v_cvt_pk_bf16_f32 v48, v16, v17
    v_mul_f32 v18, v18, v8
    v_mul_f32 v19, v19, v8
    v_cvt_pk_bf16_f32 v49, v18, v19
    v_mfma_f32_32x32x16_bf16 v[96:111], v[176:179], v[56:59], 0
    v_mul_f32 v20, v20, v8
    v_mul_f32 v21, v21, v8
    v_cvt_pk_bf16_f32 v50, v20, v21
    v_mul_f32 v22, v22, v8
    v_mul_f32 v23, v23, v8
    v_mfma_f32_32x32x16_bf16 v[112:127], v[180:183], v[56:59], 0
    v_cvt_pk_bf16_f32 v51, v22, v23
    v_mul_f32 v24, v24, v8
    v_mul_f32 v25, v25, v8
    v_cvt_pk_bf16_f32 v52, v24, v25
    v_mul_f32 v26, v26, v8
    v_mfma_f32_32x32x16_bf16 v[96:111], v[184:187], v[60:63], v[96:111]
    v_mul_f32 v27, v27, v8
    v_cvt_pk_bf16_f32 v53, v26, v27
    v_mul_f32 v28, v28, v8
    v_mul_f32 v29, v29, v8
    v_cvt_pk_bf16_f32 v54, v28, v29
    v_mfma_f32_32x32x16_bf16 v[112:127], v[188:191], v[60:63], v[112:127]
    ds_read_b64_tr_b16 v[176:177], v5 offset:3584
    ds_read_b64_tr_b16 v[178:179], v5 offset:4608
    ds_read_b64_tr_b16 v[180:181], v15 offset:3584
    ds_read_b64_tr_b16 v[182:183], v15 offset:4608
    ds_read_b64_tr_b16 v[184:185], v5 offset:5632
    ds_read_b64_tr_b16 v[186:187], v5 offset:6656
    ds_read_b64_tr_b16 v[188:189], v15 offset:5632
    ds_read_b64_tr_b16 v[190:191], v15 offset:6656
    v_mul_f32 v30, v30, v8
    v_mul_f32 v31, v31, v8
    v_cvt_pk_bf16_f32 v55, v30, v31
    v_cndmask_b32 v54, 0, v54, s[64:65]
    v_cndmask_b32 v55, 0, v55, s[64:65]
    s_waitcnt vmcnt(4)
    v_cvt_pk_bf16_f32 v144, v144, v145
    v_cvt_pk_bf16_f32 v145, v146, v147
    v_cvt_pk_bf16_f32 v146, v148, v149
    v_cvt_pk_bf16_f32 v147, v150, v151
    v_cvt_pk_bf16_f32 v148, v152, v153
    v_cvt_pk_bf16_f32 v149, v154, v155
    v_cvt_pk_bf16_f32 v150, v156, v157
    v_cvt_pk_bf16_f32 v151, v158, v159
    v_mfma_f32_32x32x16_bf16 v[16:31], v[144:147], a[32:35], 0
    v_mov_b32 v6, v44
    v_mov_b32 v8, v44
    s_nop 1
    v_permlane32_swap_b32 v6, v8
    v_add_f32 v8, s69, v8
    v_rcp_f32 v8, v8
    s_nop 0
    v_mul_f32 v32, v32, v8
    v_mfma_f32_32x32x16_bf16 v[16:31], v[148:151], a[36:39], v[16:31]
    v_mul_f32 v33, v33, v8
    v_cvt_pk_bf16_f32 v56, v32, v33
    v_mul_f32 v34, v34, v8
    v_mul_f32 v35, v35, v8
    v_cvt_pk_bf16_f32 v57, v34, v35
    s_waitcnt lgkmcnt(0)
    v_mfma_f32_32x32x16_bf16 v[64:79], v[176:179], v[48:51], v[64:79]
    v_mul_f32 v36, v36, v8
    v_mul_f32 v37, v37, v8
    v_cvt_pk_bf16_f32 v58, v36, v37
    v_mul_f32 v38, v38, v8
    v_mul_f32 v39, v39, v8
    v_mfma_f32_32x32x16_bf16 v[80:95], v[180:183], v[48:51], v[80:95]
    v_cvt_pk_bf16_f32 v59, v38, v39
    v_mul_f32 v40, v40, v8
    v_mul_f32 v41, v41, v8
    v_cvt_pk_bf16_f32 v60, v40, v41
    v_mul_f32 v42, v42, v8
    v_mfma_f32_32x32x16_bf16 v[64:79], v[184:187], v[52:55], v[64:79]
    v_mul_f32 v43, v43, v8
    v_cvt_pk_bf16_f32 v61, v42, v43
    v_mul_f32 v44, v44, v8
    v_mul_f32 v45, v45, v8
    v_cvt_pk_bf16_f32 v62, v44, v45
    v_mfma_f32_32x32x16_bf16 v[80:95], v[188:191], v[52:55], v[80:95]
    v_mul_f32 v46, v46, v8
    v_mul_f32 v47, v47, v8
    v_cvt_pk_bf16_f32 v63, v46, v47
    v_cndmask_b32 v62, 0, v62, s[64:65]
    v_cndmask_b32 v63, 0, v63, s[64:65]
    v_mfma_f32_32x32x16_bf16 v[32:47], v[144:147], a[40:43], 0
    v_mov_b32 v6, v28
    v_mov_b32 v8, v28
    s_nop 1
    v_permlane32_swap_b32 v6, v8
    v_add_f32 v8, s69, v8
    v_rcp_f32 v8, v8
    s_nop 0
    v_mul_f32 v16, v16, v8
    v_mfma_f32_32x32x16_bf16 v[32:47], v[148:151], a[44:47], v[32:47]
    v_mul_f32 v17, v17, v8
    v_cvt_pk_bf16_f32 v48, v16, v17
    v_mul_f32 v18, v18, v8
    v_mul_f32 v19, v19, v8
    v_cvt_pk_bf16_f32 v49, v18, v19
    v_mfma_f32_32x32x16_bf16 v[96:111], v[176:179], v[56:59], v[96:111]
    v_mul_f32 v20, v20, v8
    v_mul_f32 v21, v21, v8
    v_cvt_pk_bf16_f32 v50, v20, v21
    v_mul_f32 v22, v22, v8
    v_mul_f32 v23, v23, v8
    v_mfma_f32_32x32x16_bf16 v[112:127], v[180:183], v[56:59], v[112:127]
    v_cvt_pk_bf16_f32 v51, v22, v23
    v_mul_f32 v24, v24, v8
    v_mul_f32 v25, v25, v8
    v_cvt_pk_bf16_f32 v52, v24, v25
    v_mul_f32 v26, v26, v8
    v_mfma_f32_32x32x16_bf16 v[96:111], v[184:187], v[60:63], v[96:111]
    v_mul_f32 v27, v27, v8
    v_cvt_pk_bf16_f32 v53, v26, v27
    v_mul_f32 v28, v28, v8
    v_mul_f32 v29, v29, v8
    v_cvt_pk_bf16_f32 v54, v28, v29
    v_mfma_f32_32x32x16_bf16 v[112:127], v[188:191], v[60:63], v[112:127]
    ds_read_b64_tr_b16 v[176:177], v5 offset:7168
    ds_read_b64_tr_b16 v[178:179], v5 offset:8192
    ds_read_b64_tr_b16 v[180:181], v15 offset:7168
    ds_read_b64_tr_b16 v[182:183], v15 offset:8192
    ds_read_b64_tr_b16 v[184:185], v5 offset:9216
    ds_read_b64_tr_b16 v[186:187], v5 offset:10240
    ds_read_b64_tr_b16 v[188:189], v15 offset:9216
    ds_read_b64_tr_b16 v[190:191], v15 offset:10240
    v_mul_f32 v30, v30, v8
    v_mul_f32 v31, v31, v8
    v_cvt_pk_bf16_f32 v55, v30, v31
    v_cndmask_b32 v54, 0, v54, s[64:65]
    v_cndmask_b32 v55, 0, v55, s[64:65]
    s_waitcnt vmcnt(0)
    v_cvt_pk_bf16_f32 v160, v160, v161
    v_cvt_pk_bf16_f32 v161, v162, v163
    v_cvt_pk_bf16_f32 v162, v164, v165
    v_cvt_pk_bf16_f32 v163, v166, v167
    v_cvt_pk_bf16_f32 v164, v168, v169
    v_cvt_pk_bf16_f32 v165, v170, v171
    v_cvt_pk_bf16_f32 v166, v172, v173
    v_cvt_pk_bf16_f32 v167, v174, v175
    v_mfma_f32_32x32x16_bf16 v[16:31], v[160:163], a[48:51], 0
    v_mov_b32 v6, v44
    v_mov_b32 v8, v44
    s_nop 1
    v_permlane32_swap_b32 v6, v8
    v_add_f32 v8, s69, v8
    v_rcp_f32 v8, v8
    s_nop 0
    v_mul_f32 v32, v32, v8
    v_mfma_f32_32x32x16_bf16 v[16:31], v[164:167], a[52:55], v[16:31]
    v_mul_f32 v33, v33, v8
    v_cvt_pk_bf16_f32 v56, v32, v33
    v_mul_f32 v34, v34, v8
    v_mul_f32 v35, v35, v8
    v_cvt_pk_bf16_f32 v57, v34, v35
    s_waitcnt lgkmcnt(0)
    v_mfma_f32_32x32x16_bf16 v[64:79], v[176:179], v[48:51], v[64:79]
    v_mul_f32 v36, v36, v8
    v_mul_f32 v37, v37, v8
    v_cvt_pk_bf16_f32 v58, v36, v37
    v_mul_f32 v38, v38, v8
    v_mul_f32 v39, v39, v8
    v_mfma_f32_32x32x16_bf16 v[80:95], v[180:183], v[48:51], v[80:95]
    v_cvt_pk_bf16_f32 v59, v38, v39
    v_mul_f32 v40, v40, v8
    v_mul_f32 v41, v41, v8
    v_cvt_pk_bf16_f32 v60, v40, v41
    v_mul_f32 v42, v42, v8
    v_mfma_f32_32x32x16_bf16 v[64:79], v[184:187], v[52:55], v[64:79]
    v_mul_f32 v43, v43, v8
    v_cvt_pk_bf16_f32 v61, v42, v43
    v_mul_f32 v44, v44, v8
    v_mul_f32 v45, v45, v8
    v_cvt_pk_bf16_f32 v62, v44, v45
    v_mfma_f32_32x32x16_bf16 v[80:95], v[188:191], v[52:55], v[80:95]
    v_mul_f32 v46, v46, v8
    v_mul_f32 v47, v47, v8
    v_cvt_pk_bf16_f32 v63, v46, v47
    v_cndmask_b32 v62, 0, v62, s[64:65]
    v_cndmask_b32 v63, 0, v63, s[64:65]
    v_mfma_f32_32x32x16_bf16 v[32:47], v[160:163], a[56:59], 0
    v_mov_b32 v6, v28
    v_mov_b32 v8, v28
    s_nop 1
    v_permlane32_swap_b32 v6, v8
    v_add_f32 v8, s69, v8
    v_rcp_f32 v8, v8
    s_nop 0
    v_mul_f32 v16, v16, v8
    v_mfma_f32_32x32x16_bf16 v[32:47], v[164:167], a[60:63], v[32:47]
    v_mul_f32 v17, v17, v8
    v_cvt_pk_bf16_f32 v48, v16, v17
    v_mul_f32 v18, v18, v8
    v_mul_f32 v19, v19, v8
    v_cvt_pk_bf16_f32 v49, v18, v19
    v_mfma_f32_32x32x16_bf16 v[96:111], v[176:179], v[56:59], v[96:111]
    v_mul_f32 v20, v20, v8
    v_mul_f32 v21, v21, v8
    v_cvt_pk_bf16_f32 v50, v20, v21
    v_mul_f32 v22, v22, v8
    v_mul_f32 v23, v23, v8
    v_mfma_f32_32x32x16_bf16 v[112:127], v[180:183], v[56:59], v[112:127]
    v_cvt_pk_bf16_f32 v51, v22, v23
    v_mul_f32 v24, v24, v8
    v_mul_f32 v25, v25, v8
    v_cvt_pk_bf16_f32 v52, v24, v25
    v_mul_f32 v26, v26, v8
    v_mfma_f32_32x32x16_bf16 v[96:111], v[184:187], v[60:63], v[96:111]
    v_mul_f32 v27, v27, v8
    v_cvt_pk_bf16_f32 v53, v26, v27
    v_mul_f32 v28, v28, v8
    v_mul_f32 v29, v29, v8
    v_cvt_pk_bf16_f32 v54, v28, v29
    v_mfma_f32_32x32x16_bf16 v[112:127], v[188:191], v[60:63], v[112:127]
    ds_read_b64_tr_b16 v[176:177], v5 offset:10752
    ds_read_b64_tr_b16 v[178:179], v5 offset:11776
    ds_read_b64_tr_b16 v[180:181], v15 offset:10752
    ds_read_b64_tr_b16 v[182:183], v15 offset:11776
    ds_read_b64_tr_b16 v[184:185], v5 offset:12800
    ds_read_b64_tr_b16 v[186:187], v5 offset:13824
    ds_read_b64_tr_b16 v[188:189], v15 offset:12800
    ds_read_b64_tr_b16 v[190:191], v15 offset:13824
    v_mul_f32 v30, v30, v8
    v_mul_f32 v31, v31, v8
    v_cvt_pk_bf16_f32 v55, v30, v31
    v_cndmask_b32 v54, 0, v54, s[64:65]
    v_cndmask_b32 v55, 0, v55, s[64:65]
    s_waitcnt lgkmcnt(0)
    v_mfma_f32_32x32x16_bf16 v[64:79], v[176:179], v[48:51], v[64:79]
    v_mov_b32 v6, v44
    v_mov_b32 v8, v44
    s_nop 1
    v_permlane32_swap_b32 v6, v8
    v_add_f32 v8, s69, v8
    v_rcp_f32 v8, v8
    s_nop 0
    v_mul_f32 v32, v32, v8
    v_mul_f32 v33, v33, v8
    v_cvt_pk_bf16_f32 v56, v32, v33
    v_mfma_f32_32x32x16_bf16 v[80:95], v[180:183], v[48:51], v[80:95]
    v_mul_f32 v34, v34, v8
    v_mul_f32 v35, v35, v8
    v_cvt_pk_bf16_f32 v57, v34, v35
    v_mul_f32 v36, v36, v8
    v_mul_f32 v37, v37, v8
    v_cvt_pk_bf16_f32 v58, v36, v37
    v_mul_f32 v38, v38, v8
    v_mul_f32 v39, v39, v8
    v_mfma_f32_32x32x16_bf16 v[64:79], v[184:187], v[52:55], v[64:79]
    v_cvt_pk_bf16_f32 v59, v38, v39
    v_mul_f32 v40, v40, v8
    v_mul_f32 v41, v41, v8
    v_cvt_pk_bf16_f32 v60, v40, v41
    v_mul_f32 v42, v42, v8
    v_mul_f32 v43, v43, v8
    v_cvt_pk_bf16_f32 v61, v42, v43
    v_mul_f32 v44, v44, v8
    v_mfma_f32_32x32x16_bf16 v[80:95], v[188:191], v[52:55], v[80:95]
    v_mul_f32 v45, v45, v8
    v_cvt_pk_bf16_f32 v62, v44, v45
    v_mul_f32 v46, v46, v8
    v_mul_f32 v47, v47, v8
    v_cvt_pk_bf16_f32 v63, v46, v47
    v_cndmask_b32 v62, 0, v62, s[64:65]
    v_cndmask_b32 v63, 0, v63, s[64:65]
    v_mfma_f32_32x32x16_bf16 v[96:111], v[176:179], v[56:59], v[96:111]
    v_mfma_f32_32x32x16_bf16 v[112:127], v[180:183], v[56:59], v[112:127]
    ds_write_b128 v13, v[64:67] offset:0
    ds_write_b128 v13, v[68:71] offset:16
    ds_write_b128 v13, v[72:75] offset:32
    v_mfma_f32_32x32x16_bf16 v[96:111], v[184:187], v[60:63], v[96:111]
    ds_write_b128 v13, v[76:79] offset:48
    ds_write_b128 v13, v[80:83] offset:128
    ds_write_b128 v13, v[84:87] offset:144
    v_mfma_f32_32x32x16_bf16 v[112:127], v[188:191], v[60:63], v[112:127]
    ds_write_b128 v13, v[88:91] offset:160
    ds_write_b128 v13, v[92:95] offset:176
    s_nop 5
    ds_write_b128 v13, v[96:99] offset:8704
    ds_write_b128 v13, v[100:103] offset:8720
    ds_write_b128 v13, v[104:107] offset:8736
    ds_write_b128 v13, v[108:111] offset:8752
    ds_write_b128 v13, v[112:115] offset:8832
    ds_write_b128 v13, v[116:119] offset:8848
    ds_write_b128 v13, v[120:123] offset:8864
    ds_write_b128 v13, v[124:127] offset:8880
    s_waitcnt lgkmcnt(0)
    s_barrier
    ds_read_b128 v[64:67], v10 offset:0
    ds_read_b128 v[68:71], v10 offset:16
    ds_read_b128 v[72:75], v10 offset:20480
    ds_read_b128 v[76:79], v10 offset:20496
    ds_read_b128 v[80:83], v12 offset:0
    ds_read_b128 v[84:87], v12 offset:16
    ds_read_b128 v[88:91], v12 offset:20480
    ds_read_b128 v[92:95], v12 offset:20496
    ds_read_b128 v[96:99], v10 offset:8704
    ds_read_b128 v[100:103], v10 offset:8720
    ds_read_b128 v[104:107], v10 offset:29184
    ds_read_b128 v[108:111], v10 offset:29200
    ds_read_b128 v[112:115], v12 offset:8704
    ds_read_b128 v[116:119], v12 offset:8720
    ds_read_b128 v[120:123], v12 offset:29184
    ds_read_b128 v[124:127], v12 offset:29200
    s_waitcnt lgkmcnt(8)
    v_add_f32 v64, v64, v72
    v_add_f32 v80, v80, v88
    v_add_f32 v65, v65, v73
    v_add_f32 v81, v81, v89
    v_add_f32 v66, v66, v74
    v_add_f32 v82, v82, v90
    v_add_f32 v67, v67, v75
    v_add_f32 v83, v83, v91
    v_add_f32 v68, v68, v76
    v_add_f32 v84, v84, v92
    v_add_f32 v69, v69, v77
    v_add_f32 v85, v85, v93
    v_add_f32 v70, v70, v78
    v_add_f32 v86, v86, v94
    v_add_f32 v71, v71, v79
    v_add_f32 v87, v87, v95
    v_add_f32 v64, v64, v80
    v_add_f32 v65, v65, v81
    v_add_f32 v66, v66, v82
    v_add_f32 v67, v67, v83
    v_add_f32 v68, v68, v84
    v_add_f32 v69, v69, v85
    v_add_f32 v70, v70, v86
    v_add_f32 v71, v71, v87
    v_cvt_pk_bf16_f32 v72, v64, v65
    v_cvt_pk_bf16_f32 v73, v66, v67
    v_cvt_pk_bf16_f32 v74, v68, v69
    v_cvt_pk_bf16_f32 v75, v70, v71
    buffer_store_dwordx4 v[72:75], v11, s[60:63], s70 offen
    s_waitcnt lgkmcnt(0)
    v_add_f32 v96, v96, v104
    v_add_f32 v112, v112, v120
    v_add_f32 v97, v97, v105
    v_add_f32 v113, v113, v121
    v_add_f32 v98, v98, v106
    v_add_f32 v114, v114, v122
    v_add_f32 v99, v99, v107
    v_add_f32 v115, v115, v123
    v_add_f32 v100, v100, v108
    v_add_f32 v116, v116, v124
    v_add_f32 v101, v101, v109
    v_add_f32 v117, v117, v125
    v_add_f32 v102, v102, v110
    v_add_f32 v118, v118, v126
    v_add_f32 v103, v103, v111
    v_add_f32 v119, v119, v127
    v_add_f32 v96, v96, v112
    v_add_f32 v97, v97, v113
    v_add_f32 v98, v98, v114
    v_add_f32 v99, v99, v115
    v_add_f32 v100, v100, v116
    v_add_f32 v101, v101, v117
    v_add_f32 v102, v102, v118
    v_add_f32 v103, v103, v119
    v_cvt_pk_bf16_f32 v104, v96, v97
    v_cvt_pk_bf16_f32 v105, v98, v99
    v_cvt_pk_bf16_f32 v106, v100, v101
    v_cvt_pk_bf16_f32 v107, v102, v103
    buffer_store_dwordx4 v[104:107], v11, s[60:63], s71 offen
L_kvend:
    s_endpgm
L_S:
    s_load_dwordx16 s[16:31], s[0:1], 0
    s_setprio 3
    s_and_b32 s72, s2, 7
    s_lshr_b32 s73, s2, 3
    s_cmp_eq_u32 s72, 7
    s_cbranch_scc1 L_aux
    s_lshl_b32 s67, s72, 4
    s_and_b32 s74, s73, 15
    s_add_u32 s74, s74, s67
    s_lshr_b32 s75, s73, 4
    s_lshl_b32 s80, s74, 1
    s_add_u32 s80, s80, s75
    v_and_b32 v136, 31, v2
    s_cmp_eq_u32 s66, 1
    s_cselect_b32 s67, 4, 8
    s_cselect_b32 s70, 2, 8
    s_cselect_b32 s71, 256, 0
    s_cselect_b32 s79, 384, 4
    s_cmp_eq_u32 s66, 2
    s_cselect_b32 s67, 1, s67
    s_cselect_b32 s70, 1, s70
    s_cselect_b32 s71, 512, s71
    s_cselect_b32 s79, 640, s79
    s_cselect_b32 s78, 32, 1
    v_mul_u32_u24 v153, s67, v136
    v_add_u32 v153, s71, v153
    v_mul_u32_u24 v154, s70, v136
    v_add_u32 v154, s79, v154
    v_cmp_gt_u32 vcc, 32, v2
    s_lshl_b32 s67, s78, 1
    s_cmp_eq_u32 s66, 0
    s_cselect_b32 s70, 2, 64
    v_mov_b32 v138, s70
    v_mov_b32 v139, s67
    v_cndmask_b32 v153, v154, v153, vcc
    v_cndmask_b32 v139, v138, v139, vcc
    v_add_u32 v154, s78, v153
    v_add_u32 v155, v153, v139
    v_add_u32 v156, s78, v155
    v_mov_b32 v139, 66304
    v_lshl_add_u32 v153, v153, 1, v139
    v_lshl_add_u32 v154, v154, 1, v139
    v_lshl_add_u32 v155, v155, 1, v139
    v_lshl_add_u32 v156, v156, 1, v139
    v_lshlrev_b32 v138, 3, v0
    v_sub_u32 v138, 2047, v138
    v_subrev_u32 v144, 0, v138
    v_cvt_f32_i32 v96, v144
    v_subrev_u32 v145, 1, v138
    v_cvt_f32_i32 v97, v145
    v_subrev_u32 v146, 2, v138
    v_cvt_f32_i32 v98, v146
    v_subrev_u32 v147, 3, v138
    v_cvt_f32_i32 v99, v147
    v_subrev_u32 v148, 4, v138
    v_cvt_f32_i32 v100, v148
    v_subrev_u32 v149, 5, v138
    v_cvt_f32_i32 v101, v149
    v_subrev_u32 v150, 6, v138
    v_cvt_f32_i32 v102, v150
    v_subrev_u32 v151, 7, v138
    v_cvt_f32_i32 v103, v151
    v_subrev_u32 v152, 8, v138
    v_cvt_f32_i32 v104, v152
    v_cvt_pk_bf16_f32 v96, v96, v97
    v_lshrrev_b32 v97, 16, v96
    v_and_b32 v96, 0xffff, v96
    v_cvt_pk_bf16_f32 v98, v98, v99
    v_lshrrev_b32 v99, 16, v98
    v_and_b32 v98, 0xffff, v98
    v_cvt_pk_bf16_f32 v100, v100, v101
    v_lshrrev_b32 v101, 16, v100
    v_and_b32 v100, 0xffff, v100
    v_cvt_pk_bf16_f32 v102, v102, v103
    v_lshrrev_b32 v103, 16, v102
    v_and_b32 v102, 0xffff, v102
    v_cvt_pk_bf16_f32 v104, v104, v104
    v_and_b32 v104, 0xffff, v104
    v_cmp_gt_i32 vcc, 128, v144
    v_subrev_u32 v96, 17024, v96
    s_nop 0
    v_cndmask_b32 v144, v96, v144, vcc
    v_lshl_add_u32 v144, v144, 1, v139
    v_subrev_u32 v97, 17024, v97
    v_cndmask_b32 v145, v97, v145, vcc
    v_lshl_add_u32 v145, v145, 1, v139
    v_subrev_u32 v98, 17024, v98
    v_cndmask_b32 v146, v98, v146, vcc
    v_lshl_add_u32 v146, v146, 1, v139
    v_subrev_u32 v99, 17024, v99
    v_cndmask_b32 v147, v99, v147, vcc
    v_lshl_add_u32 v147, v147, 1, v139
    v_subrev_u32 v100, 17024, v100
    v_cndmask_b32 v148, v100, v148, vcc
    v_lshl_add_u32 v148, v148, 1, v139
    v_subrev_u32 v101, 17024, v101
    v_cndmask_b32 v149, v101, v149, vcc
    v_lshl_add_u32 v149, v149, 1, v139
    v_subrev_u32 v102, 17024, v102
    v_cndmask_b32 v150, v102, v150, vcc
    v_lshl_add_u32 v150, v150, 1, v139
    v_subrev_u32 v103, 17024, v103
    v_cndmask_b32 v151, v103, v151, vcc
    v_lshl_add_u32 v151, v151, 1, v139
    v_cmp_gt_i32 vcc, 128, v152
    v_subrev_u32 v104, 17024, v104
    s_nop 0
    v_cndmask_b32 v152, v104, v152, vcc
    v_lshl_add_u32 v152, v152, 1, v139
    v_and_b32 v5, 3, v2
    v_sub_u32 v5, 3, v5
    v_mul_u32_u24 v188, 4160, v5
    v_lshrrev_b32 v6, 4, v2
    v_lshl_add_u32 v188, v6, 4, v188
    v_bfe_u32 v7, v2, 2, 2
    v_lshlrev_b32 v7, 4, v7
    v_sub_u32 v188, v188, v7
    s_and_b32 s67, s66, 1
    s_lshl_b32 s67, s67, 8
    s_lshr_b32 s70, s66, 1
    s_mul_i32 s70, s70, 16640
    s_add_u32 s70, s70, 496
    s_sub_u32 s70, s70, s67
    v_add_u32 v188, s70, v188
    v_and_b32 v5, 1, v2
    v_sub_u32 v5, 1, v5
    v_mul_u32_u24 v59, 4128, v5
    v_add_u32 v59, 33280, v59
    v_bfe_u32 v5, v2, 1, 3
    v_lshl_add_u32 v189, v5, 6, v59
    v_lshl_add_u32 v189, v6, 4, v189
    s_sub_u32 s70, 16, s67
    v_add_u32 v189, s70, v189
    s_lshl_b32 s68, s80, 10
    s_lshl_b32 s69, s66, 7
    s_add_u32 s68, s68, s69
    v_lshrrev_b32 v7, 5, v2
    v_lshlrev_b32 v5, 2, v136
    v_lshl_add_u32 v6, v7, 9, v5
    v_add_u32 v40, s68, v6
    s_lshl_b32 s68, s80, 2
    v_lshl_add_u32 v6, v7, 1, s68
    s_lshl_b32 s68, s73, 2
    s_add_u32 s68, s68, s66
    s_mul_i32 s68, s68, 14336
    s_lshl_b32 s69, s72, 7
    s_add_u32 s68, s68, s69
    v_mul_u32_u24 v7, 7168, v7
    v_add3_u32 v7, v7, v5, s68
    v_add_u32 v5, 3584, v7
    s_waitcnt lgkmcnt(0)
    global_load_short_d16_hi v14, v6, s[30:31]
    global_load_dword v16, v40, s[18:19] nt
    global_load_dword v17, v40, s[20:21] nt
    global_load_dword v18, v40, s[22:23] nt
    global_load_dword v19, v40, s[24:25] nt
    global_load_dword v20, v40, s[26:27] nt
    global_load_dword v21, v40, s[28:29] nt
    global_load_short_d16_hi v15, v6, s[32:33]
    global_load_dwordx2 v[190:191], v4, s[42:43] sc1
    global_load_dword v80, v7, s[16:17] offset:0 nt
    global_load_dword v81, v7, s[16:17] offset:896 nt
    global_load_dword v82, v7, s[16:17] offset:1792 nt
    global_load_dword v83, v7, s[16:17] offset:2688 nt
    global_load_dword v84, v5, s[16:17] offset:0 nt
    global_load_dword v85, v5, s[16:17] offset:896 nt
    global_load_dword v86, v5, s[16:17] offset:1792 nt
    global_load_dword v87, v5, s[16:17] offset:2688 nt
    s_setprio 2
    s_mov_b32 s48, s44
    s_mov_b32 s49, s45
    s_mov_b32 s50, 7340032
    s_mov_b32 s51, 0x20000
    s_mov_b32 s60, s40
    s_mov_b32 s61, s41
    s_mov_b32 s62, 3670016
    s_mov_b32 s63, 0x20000
    s_memrealtime s[12:13]
    s_mul_i32 s76, s66, 14416
    v_and_b32 v136, 31, v2
    v_lshrrev_b32 v137, 5, v2
    v_lshlrev_b32 v137, 4, v137
    v_add_u32 v137, s76, v137
    v_min_u32 v138, 20, v136
    v_mul_u32_u24 v138, 272, v138
    v_add_u32 v60, v138, v137
    v_mul_u32_u24 v138, 272, v136
    v_add_u32 v61, v138, v137
    s_mov_b32 m0, s76
    v_add_u32 v176, s76, v3
    s_lshl_b32 s67, s66, 10
    v_add_u32 v177, s67, v3
    v_mul_u32_u24 v159, 288, v136
    v_lshrrev_b32 v138, 5, v2
    v_lshl_add_u32 v159, v138, 4, v159
    s_mov_b32 s81, 0x05040100
    v_mov_b32 v22, s81
    s_mov_b32 s81, 0x07060302
    v_mov_b32 v23, s81
    s_lshl_b32 s67, s66, 5
    s_add_u32 s67, s67, 57664
    v_add_u32 v159, s67, v159
    v_lshrrev_b32 v138, 3, v2
    v_and_b32 v139, 7, v2
    v_lshrrev_b32 v63, 3, v2
    v_and_b32 v178, 7, v2
    v_mul_u32_u24 v62, 144, v63
    v_lshl_add_u32 v62, v178, 4, v62
    s_mul_i32 s67, s66, 2304
    s_add_u32 s67, s67, 57664
    v_add_u32 v62, s67, v62
    v_lshlrev_b32 v63, 12, v63
    v_lshl_add_u32 v63, v178, 4, v63
    v_mul_u32_u24 v178, 4160, v138
    v_lshl_add_u32 v178, v139, 3, v178
    v_add_u32 v178, 4088, v178
    v_and_b32 v139, 23, v2
    v_cmp_eq_u32 vcc, 0, v139
    v_add_u32 v139, 56, v178
    v_bfe_u32 v179, v2, 1, 2
    v_mul_u32_u24 v179, 8256, v179
    v_cndmask_b32 v178, v178, v139, vcc
    v_and_b32 v139, 1, v2
    v_mul_u32_u24 v139, 4128, v139
    v_add3_u32 v179, v179, v139, s67
    s_add_u32 s67, s67, 4294934016
    v_subrev_u32 v179, s67, v179
    s_lshl_b32 s67, s72, 2
    s_add_u32 s67, s67, s66
    s_lshl_b32 s68, s67, 16
    s_lshl_b32 s69, s73, 7
    s_add_u32 s68, s68, s69
    s_add_u32 s68, s68, 5242880
    s_lshl_b32 s67, s67, 5
    s_add_u32 s67, s67, s73
    s_lshl_b32 s67, s67, 7
    s_add_u32 s77, s67, 2162688
    s_lshr_b32 s67, s74, 2
    s_lshl_b32 s67, s67, 12
    s_add_u32 s67, s67, 2162688
    s_cmp_eq_u32 s75, 1
    s_cselect_b32 s70, 15, 31
    v_and_b32 v157, s70, v2
    v_lshlrev_b32 v157, 7, v157
    v_add_u32 v157, s67, v157
    s_xor_b32 s67, s80, 1
    s_lshl_b32 s67, s67, 9
    s_add_u32 s67, s67, 2277376
    v_and_b32 v158, 3, v2
    v_lshlrev_b32 v158, 7, v158
    v_add_u32 v158, s67, v158
    s_lshl_b32 s67, s80, 2
    s_add_u32 s67, s67, s66
    s_lshl_b32 s67, s67, 7
    s_add_u32 s81, s67, 2277376
    v_lshlrev_b32 v180, 4, v0
    s_mul_i32 s70, s75, 0x7fff0000
    v_add_u32 v187, s70, v3
    s_cmp_eq_u32 s75, 0
    s_cselect_b32 s70, 2048, 0
    v_mov_b32 v58, 0x7fff0000
    v_cmp_le_u32 vcc, s70, v180
    s_nop 1
    v_cndmask_b32 v58, v58, v180, vcc
    v_add_u32 v181, 8312, v180
    v_add_u32 v182, 12472, v180
    v_add_u32 v183, 24952, v180
    v_add_u32 v184, 29112, v180
    s_mul_i32 s67, s66, 8256
    s_add_u32 s67, s67, 33280
    v_add_u32 v185, s67, v3
    s_waitcnt vmcnt(9)
    v_mul_f32 v14, 1069066811, v14
    v_exp_f32 v14, v14
    s_nop 0
    v_cvt_pk_bf16_f32 v14, v14, v14
    v_lshlrev_b32 v14, 16, v14
    v_lshlrev_b32 v8, 16, v16
    v_lshlrev_b32 v9, 16, v17
    v_lshlrev_b32 v10, 16, v18
    v_lshlrev_b32 v11, 16, v19
    v_lshlrev_b32 v12, 16, v20
    v_lshlrev_b32 v13, 16, v21
    v_mul_f32 v137, v14, v8
    v_mul_f32 v138, v14, v9
    v_mul_f32 v137, 1069066811, v137
    v_mul_f32 v138, 1042479491, v138
    v_mul_f32 v10, v14, v10
    v_mul_f32 v11, v14, v11
    v_mul_f32 v122, v12, v10
    v_mul_f32 v123, v12, v11
    v_fma_f32 v122, -v13, v11, v122
    v_fmac_f32 v123, v13, v10
    v_mul_f32 v136, 0x41000000, v137
    v_mul_f32 v139, 0x41000000, v138
    v_exp_f32 v136, v136
    v_fract_f32 v139, v139
    v_cos_f32 v114, v139
    v_sin_f32 v115, v139
    v_mul_f32 v114, v114, v136
    v_mul_f32_e64 v115, -v115, v136
    v_exp_f32 v136, v137
    v_fract_f32 v139, v138
    v_cos_f32 v112, v139
    v_sin_f32 v113, v139
    v_mul_f32 v112, v112, v136
    v_mul_f32_e64 v113, v113, v136
    v_mul_f32 v136, 0x43800000, v137
    v_mul_f32 v139, 0x43800000, v138
    v_exp_f32 v136, v136
    v_fract_f32 v139, v139
    v_cos_f32 v116, v139
    v_sin_f32 v117, v139
    v_mul_f32 v116, v116, v136
    v_mul_f32_e64 v117, v117, v136
    v_mul_f32 v118, v112, v112
    v_mul_f32 v119, v112, v113
    v_fma_f32 v118, -v113, v113, v118
    v_fmac_f32 v119, v113, v112
    v_mul_f32 v120, v118, v118
    v_mul_f32 v121, v118, v119
    v_fma_f32 v120, -v119, v119, v120
    v_fmac_f32 v121, v119, v118
    v_mov_b32 v136, 0x3f80
    ds_write_addtid_b32 v136 offset:5712
    v_cvt_pk_bf16_f32 v140, v114, v115
    ds_write_addtid_b32 v140 offset:5984
    v_cvt_pk_bf16_f32 v141, v122, v123
    ds_write_addtid_b32 v141 offset:0
    v_mul_f32 v124, v114, v114
    v_mul_f32 v125, v114, v115
    v_fma_f32 v124, -v115, v115, v124
    v_fmac_f32 v125, v115, v114
    v_cvt_pk_bf16_f32 v142, v124, v125
    ds_write_addtid_b32 v142 offset:6256
    v_mul_f32 v132, v122, v112
    v_mul_f32 v133, v122, v113
    v_fma_f32 v132, -v123, v113, v132
    v_fmac_f32 v133, v123, v112
    v_cvt_pk_bf16_f32 v143, v132, v133
    ds_write_addtid_b32 v143 offset:272
    v_mul_f32 v126, v124, v114
    v_mul_f32 v127, v124, v115
    v_fma_f32 v126, -v125, v115, v126
    v_fmac_f32 v127, v125, v114
    v_cvt_pk_bf16_f32 v140, v126, v127
    ds_write_addtid_b32 v140 offset:6528
    v_mul_f32 v134, v132, v112
    v_mul_f32 v135, v132, v113
    v_fma_f32 v134, -v133, v113, v134
    v_fmac_f32 v135, v133, v112
    v_cvt_pk_bf16_f32 v141, v134, v135
    ds_write_addtid_b32 v141 offset:544
    v_mul_f32 v124, v126, v114
    v_mul_f32 v125, v126, v115
    v_fma_f32 v124, -v127, v115, v124
    v_fmac_f32 v125, v127, v114
    v_cvt_pk_bf16_f32 v142, v124, v125
    ds_write_addtid_b32 v142 offset:6800
    v_mul_f32 v132, v134, v112
    v_mul_f32 v133, v134, v113
    v_fma_f32 v132, -v135, v113, v132
    v_fmac_f32 v133, v135, v112
    v_cvt_pk_bf16_f32 v143, v132, v133
    ds_write_addtid_b32 v143 offset:816
    v_mul_f32 v126, v124, v114
    v_mul_f32 v127, v124, v115
    v_fma_f32 v126, -v125, v115, v126
    v_fmac_f32 v127, v125, v114
    v_cvt_pk_bf16_f32 v140, v126, v127
    ds_write_addtid_b32 v140 offset:7072
    v_mul_f32 v134, v132, v112
    v_mul_f32 v135, v132, v113
    v_fma_f32 v134, -v133, v113, v134
    v_fmac_f32 v135, v133, v112
    v_cvt_pk_bf16_f32 v141, v134, v135
    ds_write_addtid_b32 v141 offset:1088
    v_mul_f32 v124, v126, v114
    v_mul_f32 v125, v126, v115
    v_fma_f32 v124, -v127, v115, v124
    v_fmac_f32 v125, v127, v114
    v_cvt_pk_bf16_f32 v142, v124, v125
    ds_write_addtid_b32 v142 offset:7344
    v_mul_f32 v132, v134, v112
    v_mul_f32 v133, v134, v113
    v_fma_f32 v132, -v135, v113, v132
    v_fmac_f32 v133, v135, v112
    v_cvt_pk_bf16_f32 v143, v132, v133
    ds_write_addtid_b32 v143 offset:1360
    v_mul_f32 v126, v124, v114
    v_mul_f32 v127, v124, v115
    v_fma_f32 v126, -v125, v115, v126
    v_fmac_f32 v127, v125, v114
    v_cvt_pk_bf16_f32 v140, v126, v127
    ds_write_addtid_b32 v140 offset:7616
    v_mul_f32 v134, v132, v112
    v_mul_f32 v135, v132, v113
    v_fma_f32 v134, -v133, v113, v134
    v_fmac_f32 v135, v133, v112
    v_cvt_pk_bf16_f32 v141, v134, v135
    ds_write_addtid_b32 v141 offset:1632
    v_mul_f32 v124, v126, v114
    v_mul_f32 v125, v126, v115
    v_fma_f32 v124, -v127, v115, v124
    v_fmac_f32 v125, v127, v114
    v_cvt_pk_bf16_f32 v142, v124, v125
    ds_write_addtid_b32 v142 offset:7888
    v_mul_f32 v132, v134, v112
    v_mul_f32 v133, v134, v113
    v_fma_f32 v132, -v135, v113, v132
    v_fmac_f32 v133, v135, v112
    v_cvt_pk_bf16_f32 v143, v132, v133
    ds_write_addtid_b32 v143 offset:1904
    v_mul_f32 v126, v124, v114
    v_mul_f32 v127, v124, v115
    v_fma_f32 v126, -v125, v115, v126
    v_fmac_f32 v127, v125, v114
    v_cvt_pk_bf16_f32 v140, v126, v127
    ds_write_addtid_b32 v140 offset:8160
    v_mul_f32 v128, v122, v116
    v_mul_f32 v129, v122, v117
    v_fma_f32 v128, -v123, v117, v128
    v_fmac_f32 v129, v123, v116
    v_cvt_pk_bf16_f32 v141, v128, v129
    ds_write_addtid_b32 v141 offset:2176
    v_mul_f32 v124, v126, v114
    v_mul_f32 v125, v126, v115
    v_fma_f32 v124, -v127, v115, v124
    v_fmac_f32 v125, v127, v114
    v_cvt_pk_bf16_f32 v142, v124, v125
    ds_write_addtid_b32 v142 offset:8432
    s_waitcnt vmcnt(0)
    s_waitcnt lgkmcnt(0)
    s_mov_b32 s13, 200
Li_13:
    v_readfirstlane_b32 s46, v190
    v_readfirstlane_b32 s47, v191
    s_sub_u32 s3, s46, s12
    s_cmp_eq_u32 s46, 0
    s_cbranch_scc1 Lir_15
    s_cmp_gt_i32 s3, -900
    s_cbranch_scc1 Lio_14
    s_sub_u32 s13, s13, 1
    s_cbranch_scc1 Lio_14
Lir_15:
    s_sub_u32 s15, s15, 1
    s_cbranch_scc1 L_end
    s_sleep 1
    global_load_dwordx2 v[190:191], v4, s[42:43] sc1
    s_waitcnt vmcnt(0)
    s_branch Li_13
Lio_14:
    v_perm_b32 v160, v81, v80, v22
    v_perm_b32 v164, v81, v80, v23
    v_perm_b32 v161, v83, v82, v22
    v_perm_b32 v165, v83, v82, v23
    v_perm_b32 v162, v85, v84, v22
    v_perm_b32 v166, v85, v84, v23
    v_perm_b32 v163, v87, v86, v22
    v_perm_b32 v167, v87, v86, v23
    ds_write_b128 v159, v[160:163] offset:0
    ds_write_b128 v159, v[164:167] offset:144
    s_waitcnt lgkmcnt(0)
    s_barrier
    ds_read_b128 v[160:163], v62 offset:0
    ds_read_b128 v[164:167], v62 offset:1152
    s_waitcnt lgkmcnt(1)
    buffer_store_dwordx4 v[160:163], v63, s[48:51], s68 offen sc1
    s_add_u32 s68, s68, 32768
    s_waitcnt lgkmcnt(0)
    buffer_store_dwordx4 v[164:167], v63, s[48:51], s68 offen sc1
    v_mul_f32 v132, v128, v118
    v_mul_f32 v133, v128, v119
    v_fma_f32 v132, -v129, v119, v132
    v_fmac_f32 v133, v129, v118
    v_cvt_pk_bf16_f32 v143, v132, v133
    ds_write_addtid_b32 v143 offset:2448
    v_mul_f32 v126, v124, v114
    v_mul_f32 v127, v124, v115
    v_fma_f32 v126, -v125, v115, v126
    v_fmac_f32 v127, v125, v114
    v_cvt_pk_bf16_f32 v140, v126, v127
    ds_write_addtid_b32 v140 offset:8704
    v_mul_f32 v134, v132, v118
    v_mul_f32 v135, v132, v119
    v_fma_f32 v134, -v133, v119, v134
    v_fmac_f32 v135, v133, v118
    v_cvt_pk_bf16_f32 v141, v134, v135
    ds_write_addtid_b32 v141 offset:2720
    v_mul_f32 v124, v126, v114
    v_mul_f32 v125, v126, v115
    v_fma_f32 v124, -v127, v115, v124
    v_fmac_f32 v125, v127, v114
    v_cvt_pk_bf16_f32 v142, v124, v125
    ds_write_addtid_b32 v142 offset:8976
    v_mul_f32 v132, v134, v118
    v_mul_f32 v133, v134, v119
    v_fma_f32 v132, -v135, v119, v132
    v_fmac_f32 v133, v135, v118
    v_cvt_pk_bf16_f32 v143, v132, v133
    ds_write_addtid_b32 v143 offset:2992
    v_mul_f32 v126, v124, v114
    v_mul_f32 v127, v124, v115
    v_fma_f32 v126, -v125, v115, v126
    v_fmac_f32 v127, v125, v114
    v_cvt_pk_bf16_f32 v140, v126, v127
    ds_write_addtid_b32 v140 offset:9248
    v_mul_f32 v130, v128, v116
    v_mul_f32 v131, v128, v117
    v_fma_f32 v130, -v129, v117, v130
    v_fmac_f32 v131, v129, v116
    v_cvt_pk_bf16_f32 v141, v130, v131
    ds_write_addtid_b32 v141 offset:3264
    v_mul_f32 v124, v126, v114
    v_mul_f32 v125, v126, v115
    v_fma_f32 v124, -v127, v115, v124
    v_fmac_f32 v125, v127, v114
    v_cvt_pk_bf16_f32 v142, v124, v125
    ds_write_addtid_b32 v142 offset:9520
    v_mul_f32 v132, v130, v120
    v_mul_f32 v133, v130, v121
    v_fma_f32 v132, -v131, v121, v132
    v_fmac_f32 v133, v131, v120
    v_cvt_pk_bf16_f32 v143, v132, v133
    ds_write_addtid_b32 v143 offset:3536
    v_mul_f32 v126, v124, v114
    v_mul_f32 v127, v124, v115
    v_fma_f32 v126, -v125, v115, v126
    v_fmac_f32 v127, v125, v114
    v_cvt_pk_bf16_f32 v140, v126, v127
    ds_write_addtid_b32 v140 offset:9792
    v_mul_f32 v128, v130, v116
    v_mul_f32 v129, v130, v117
    v_fma_f32 v128, -v131, v117, v128
    v_fmac_f32 v129, v131, v116
    v_cvt_pk_bf16_f32 v141, v128, v129
    ds_write_addtid_b32 v141 offset:3808
    v_mul_f32 v124, v126, v114
    v_mul_f32 v125, v126, v115
    v_fma_f32 v124, -v127, v115, v124
    v_fmac_f32 v125, v127, v114
    v_cvt_pk_bf16_f32 v142, v124, v125
    ds_write_addtid_b32 v142 offset:10064
    v_mul_f32 v132, v128, v120
    v_mul_f32 v133, v128, v121
    v_fma_f32 v132, -v129, v121, v132
    v_fmac_f32 v133, v129, v120
    v_cvt_pk_bf16_f32 v143, v132, v133
    ds_write_addtid_b32 v143 offset:4080
    v_mul_f32 v126, v124, v114
    v_mul_f32 v127, v124, v115
    v_fma_f32 v126, -v125, v115, v126
    v_fmac_f32 v127, v125, v114
    v_cvt_pk_bf16_f32 v140, v126, v127
    ds_write_addtid_b32 v140 offset:10336
    v_mul_f32 v130, v128, v116
    v_mul_f32 v131, v128, v117
    v_fma_f32 v130, -v129, v117, v130
    v_fmac_f32 v131, v129, v116
    v_cvt_pk_bf16_f32 v141, v130, v131
    ds_write_addtid_b32 v141 offset:4352
    v_mul_f32 v124, v126, v114
    v_mul_f32 v125, v126, v115
    v_fma_f32 v124, -v127, v115, v124
    v_fmac_f32 v125, v127, v114
    v_cvt_pk_bf16_f32 v142, v124, v125
    ds_write_addtid_b32 v142 offset:10608
    v_mul_f32 v128, v130, v116
    v_mul_f32 v129, v130, v117
    v_fma_f32 v128, -v131, v117, v128
    v_fmac_f32 v129, v131, v116
    v_cvt_pk_bf16_f32 v143, v128, v129
    ds_write_addtid_b32 v143 offset:4624
    v_mul_f32 v126, v124, v114
    v_mul_f32 v127, v124, v115
    v_fma_f32 v126, -v125, v115, v126
    v_fmac_f32 v127, v125, v114
    v_cvt_pk_bf16_f32 v140, v126, v127
    ds_write_addtid_b32 v140 offset:10880
    v_mul_f32 v130, v128, v116
    v_mul_f32 v131, v128, v117
    v_fma_f32 v130, -v129, v117, v130
    v_fmac_f32 v131, v129, v116
    v_cvt_pk_bf16_f32 v141, v130, v131
    ds_write_addtid_b32 v141 offset:4896
    v_mul_f32 v124, v126, v114
    v_mul_f32 v125, v126, v115
    v_fma_f32 v124, -v127, v115, v124
    v_fmac_f32 v125, v127, v114
    v_cvt_pk_bf16_f32 v142, v124, v125
    ds_write_addtid_b32 v142 offset:11152
    v_mul_f32 v128, v130, v116
    v_mul_f32 v129, v130, v117
    v_fma_f32 v128, -v131, v117, v128
    v_fmac_f32 v129, v131, v116
    v_cvt_pk_bf16_f32 v143, v128, v129
    ds_write_addtid_b32 v143 offset:5168
    v_mul_f32 v126, v124, v114
    v_mul_f32 v127, v124, v115
    v_fma_f32 v126, -v125, v115, v126
    v_fmac_f32 v127, v125, v114
    v_cvt_pk_bf16_f32 v140, v126, v127
    ds_write_addtid_b32 v140 offset:11424
    v_mul_f32 v130, v128, v116
    v_mul_f32 v131, v128, v117
    v_fma_f32 v130, -v129, v117, v130
    v_fmac_f32 v131, v129, v116
    v_cvt_pk_bf16_f32 v141, v130, v131
    ds_write_addtid_b32 v141 offset:5440
    v_mul_f32 v124, v126, v114
    v_mul_f32 v125, v126, v115
    v_fma_f32 v124, -v127, v115, v124
    v_fmac_f32 v125, v127, v114
    v_cvt_pk_bf16_f32 v142, v124, v125
    ds_write_addtid_b32 v142 offset:11696
    v_mul_f32 v126, v124, v114
    v_mul_f32 v127, v124, v115
    v_fma_f32 v126, -v125, v115, v126
    v_fmac_f32 v127, v125, v114
    v_cvt_pk_bf16_f32 v143, v126, v127
    ds_write_addtid_b32 v143 offset:11968
    v_mul_f32 v124, v126, v114
    v_mul_f32 v125, v126, v115
    v_fma_f32 v124, -v127, v115, v124
    v_fmac_f32 v125, v127, v114
    v_cvt_pk_bf16_f32 v140, v124, v125
    ds_write_addtid_b32 v140 offset:12240
    v_mul_f32 v126, v124, v114
    v_mul_f32 v127, v124, v115
    v_fma_f32 v126, -v125, v115, v126
    v_fmac_f32 v127, v125, v114
    v_cvt_pk_bf16_f32 v141, v126, v127
    ds_write_addtid_b32 v141 offset:12512
    v_mul_f32 v124, v126, v114
    v_mul_f32 v125, v126, v115
    v_fma_f32 v124, -v127, v115, v124
    v_fmac_f32 v125, v127, v114
    v_cvt_pk_bf16_f32 v142, v124, v125
    ds_write_addtid_b32 v142 offset:12784
    v_mul_f32 v126, v124, v114
    v_mul_f32 v127, v124, v115
    v_fma_f32 v126, -v125, v115, v126
    v_fmac_f32 v127, v125, v114
    v_cvt_pk_bf16_f32 v143, v126, v127
    ds_write_addtid_b32 v143 offset:13056
    v_mul_f32 v124, v126, v114
    v_mul_f32 v125, v126, v115
    v_fma_f32 v124, -v127, v115, v124
    v_fmac_f32 v125, v127, v114
    v_cvt_pk_bf16_f32 v140, v124, v125
    ds_write_addtid_b32 v140 offset:13328
    v_mul_f32 v126, v124, v114
    v_mul_f32 v127, v124, v115
    v_fma_f32 v126, -v125, v115, v126
    v_fmac_f32 v127, v125, v114
    v_cvt_pk_bf16_f32 v141, v126, v127
    ds_write_addtid_b32 v141 offset:13600
    v_mul_f32 v124, v126, v114
    v_mul_f32 v125, v126, v115
    v_fma_f32 v124, -v127, v115, v124
    v_fmac_f32 v125, v127, v114
    v_cvt_pk_bf16_f32 v142, v124, v125
    ds_write_addtid_b32 v142 offset:13872
    v_mul_f32 v126, v124, v114
    v_mul_f32 v127, v124, v115
    v_fma_f32 v126, -v125, v115, v126
    v_fmac_f32 v127, v125, v114
    v_cvt_pk_bf16_f32 v143, v126, v127
    ds_write_addtid_b32 v143 offset:14144
    s_waitcnt vmcnt(0)
    s_mov_b64 exec, 1
    buffer_store_dwordx2 v[190:191], off, s[48:51], s77 sc1
    s_mov_b64 exec, -1
    s_waitcnt lgkmcnt(0)
    ds_read_b128 v[96:99], v60 offset:0
    ds_read_b128 v[100:103], v61 offset:5712
    ds_read_b128 v[104:107], v60 offset:32
    ds_read_b128 v[108:111], v61 offset:5744
    ds_read_b128 v[40:43], v60 offset:64
    ds_read_b128 v[44:47], v61 offset:5776
    ds_read_b128 v[48:51], v60 offset:96
    ds_read_b128 v[52:55], v61 offset:5808
    v_and_b32 v8, 0xffff0000, v16
    v_and_b32 v9, 0xffff0000, v17
    v_and_b32 v10, 0xffff0000, v18
    v_and_b32 v11, 0xffff0000, v19
    v_and_b32 v12, 0xffff0000, v20
    v_and_b32 v13, 0xffff0000, v21
    v_mul_f32 v137, v14, v8
    v_mul_f32 v138, v14, v9
    v_mul_f32 v137, 1069066811, v137
    v_mul_f32 v138, 1042479491, v138
    v_mul_f32 v10, v14, v10
    v_mul_f32 v11, v14, v11
    v_mul_f32 v122, v12, v10
    v_mul_f32 v123, v12, v11
    v_fma_f32 v122, -v13, v11, v122
    v_fmac_f32 v123, v13, v10
    v_mul_f32 v136, 0x41000000, v137
    v_mul_f32 v139, 0x41000000, v138
    v_exp_f32 v136, v136
    v_fract_f32 v139, v139
    v_cos_f32 v114, v139
    v_sin_f32 v115, v139
    v_mul_f32 v114, v114, v136
    v_mul_f32_e64 v115, -v115, v136
    v_exp_f32 v136, v137
    v_fract_f32 v139, v138
    v_cos_f32 v112, v139
    v_sin_f32 v113, v139
    v_mul_f32 v112, v112, v136
    v_mul_f32_e64 v113, v113, v136
    v_mul_f32 v136, 0x43800000, v137
    v_mul_f32 v139, 0x43800000, v138
    v_exp_f32 v136, v136
    v_fract_f32 v139, v139
    v_cos_f32 v116, v139
    v_sin_f32 v117, v139
    v_mul_f32 v116, v116, v136
    v_mul_f32_e64 v117, v117, v136
    v_mul_f32 v118, v112, v112
    v_mul_f32 v119, v112, v113
    v_fma_f32 v118, -v113, v113, v118
    v_fmac_f32 v119, v113, v112
    v_mul_f32 v120, v118, v118
    v_mul_f32 v121, v118, v119
    v_fma_f32 v120, -v119, v119, v120
    v_fmac_f32 v121, v119, v118
    v_readlane_b32 s67, v15, 32
    v_cmp_eq_u32 vcc, 0, v0
    s_nop 0
    v_mov_b32 v23, s67
    v_cndmask_b32 v15, 0, v15, vcc
    v_cndmask_b32 v23, 0, v23, vcc
    s_waitcnt lgkmcnt(6)
    v_mfma_f32_32x32x16_bf16 v[64:79], v[96:99], v[100:103], 0
    ds_read_b128 v[96:99], v60 offset:128
    ds_read_b128 v[100:103], v61 offset:5840
    s_waitcnt lgkmcnt(6)
    v_mfma_f32_32x32x16_bf16 v[64:79], v[104:107], v[108:111], v[64:79]
    ds_read_b128 v[104:107], v60 offset:160
    ds_read_b128 v[108:111], v61 offset:5872
    s_waitcnt lgkmcnt(6)
    v_mfma_f32_32x32x16_bf16 v[64:79], v[40:43], v[44:47], v[64:79]
    ds_read_b128 v[40:43], v60 offset:192
    ds_read_b128 v[44:47], v61 offset:5904
    s_waitcnt lgkmcnt(6)
    v_mfma_f32_32x32x16_bf16 v[64:79], v[48:51], v[52:55], v[64:79]
    ds_read_b128 v[48:51], v60 offset:224
    ds_read_b128 v[52:55], v61 offset:5936
    s_waitcnt lgkmcnt(6)
    v_mfma_f32_32x32x16_bf16 v[80:95], v[96:99], v[100:103], 0
    s_waitcnt lgkmcnt(4)
    v_mfma_f32_32x32x16_bf16 v[80:95], v[104:107], v[108:111], v[80:95]
    s_waitcnt lgkmcnt(2)
    v_mfma_f32_32x32x16_bf16 v[80:95], v[40:43], v[44:47], v[80:95]
    s_waitcnt lgkmcnt(0)
    v_mfma_f32_32x32x16_bf16 v[80:95], v[48:51], v[52:55], v[80:95]
    v_cvt_pk_bf16_f32 v140, v114, v115
    ds_write_addtid_b32 v140 offset:5984
    v_cvt_pk_bf16_f32 v141, v122, v123
    ds_write_addtid_b32 v141 offset:0
    v_mul_f32 v124, v114, v114
    v_mul_f32 v125, v114, v115
    v_fma_f32 v124, -v115, v115, v124
    v_fmac_f32 v125, v115, v114
    v_cvt_pk_bf16_f32 v142, v124, v125
    ds_write_addtid_b32 v142 offset:6256
    v_mul_f32 v132, v122, v112
    v_mul_f32 v133, v122, v113
    v_fma_f32 v132, -v123, v113, v132
    v_fmac_f32 v133, v123, v112
    v_cvt_pk_bf16_f32 v143, v132, v133
    ds_write_addtid_b32 v143 offset:272
    v_mul_f32 v126, v124, v114
    v_mul_f32 v127, v124, v115
    v_fma_f32 v126, -v125, v115, v126
    v_fmac_f32 v127, v125, v114
    v_cvt_pk_bf16_f32 v140, v126, v127
    ds_write_addtid_b32 v140 offset:6528
    v_mul_f32 v134, v132, v112
    v_mul_f32 v135, v132, v113
    v_fma_f32 v134, -v133, v113, v134
    v_fmac_f32 v135, v133, v112
    v_cvt_pk_bf16_f32 v141, v134, v135
    ds_write_addtid_b32 v141 offset:544
    v_mul_f32 v124, v126, v114
    v_mul_f32 v125, v126, v115
    v_fma_f32 v124, -v127, v115, v124
    v_fmac_f32 v125, v127, v114
    v_cvt_pk_bf16_f32 v142, v124, v125
    ds_write_addtid_b32 v142 offset:6800
    v_mul_f32 v132, v134, v112
    v_mul_f32 v133, v134, v113
    v_fma_f32 v132, -v135, v113, v132
    v_fmac_f32 v133, v135, v112
    v_cvt_pk_bf16_f32 v143, v132, v133
    ds_write_addtid_b32 v143 offset:816
    v_mul_f32 v126, v124, v114
    v_mul_f32 v127, v124, v115
    v_fma_f32 v126, -v125, v115, v126
    v_fmac_f32 v127, v125, v114
    v_cvt_pk_bf16_f32 v140, v126, v127
    ds_write_addtid_b32 v140 offset:7072
    v_mul_f32 v134, v132, v112
    v_mul_f32 v135, v132, v113
    v_fma_f32 v134, -v133, v113, v134
    v_fmac_f32 v135, v133, v112
    v_cvt_pk_bf16_f32 v141, v134, v135
    ds_write_addtid_b32 v141 offset:1088
    v_mul_f32 v124, v126, v114
    v_mul_f32 v125, v126, v115
    v_fma_f32 v124, -v127, v115, v124
    v_fmac_f32 v125, v127, v114
    v_cvt_pk_bf16_f32 v142, v124, v125
    ds_write_addtid_b32 v142 offset:7344
    v_mul_f32 v132, v134, v112
    v_mul_f32 v133, v134, v113
    v_fma_f32 v132, -v135, v113, v132
    v_fmac_f32 v133, v135, v112
    v_cvt_pk_bf16_f32 v143, v132, v133
    ds_write_addtid_b32 v143 offset:1360
    v_mul_f32 v126, v124, v114
    v_mul_f32 v127, v124, v115
    v_fma_f32 v126, -v125, v115, v126
    v_fmac_f32 v127, v125, v114
    v_cvt_pk_bf16_f32 v140, v126, v127
    ds_write_addtid_b32 v140 offset:7616
    v_mul_f32 v134, v132, v112
    v_mul_f32 v135, v132, v113
    v_fma_f32 v134, -v133, v113, v134
    v_fmac_f32 v135, v133, v112
    v_cvt_pk_bf16_f32 v141, v134, v135
    ds_write_addtid_b32 v141 offset:1632
    v_mul_f32 v124, v126, v114
    v_mul_f32 v125, v126, v115
    v_fma_f32 v124, -v127, v115, v124
    v_fmac_f32 v125, v127, v114
    v_cvt_pk_bf16_f32 v142, v124, v125
    ds_write_addtid_b32 v142 offset:7888
    v_mul_f32 v132, v134, v112
    v_mul_f32 v133, v134, v113
    v_fma_f32 v132, -v135, v113, v132
    v_fmac_f32 v133, v135, v112
    v_cvt_pk_bf16_f32 v143, v132, v133
    ds_write_addtid_b32 v143 offset:1904
    v_mul_f32 v126, v124, v114
    v_mul_f32 v127, v124, v115
    v_fma_f32 v126, -v125, v115, v126
    v_fmac_f32 v127, v125, v114
    v_cvt_pk_bf16_f32 v140, v126, v127
    ds_write_addtid_b32 v140 offset:8160
    v_mul_f32 v128, v122, v116
    v_mul_f32 v129, v122, v117
    v_fma_f32 v128, -v123, v117, v128
    v_fmac_f32 v129, v123, v116
    v_cvt_pk_bf16_f32 v141, v128, v129
    ds_write_addtid_b32 v141 offset:2176
    v_mul_f32 v124, v126, v114
    v_mul_f32 v125, v126, v115
    v_fma_f32 v124, -v127, v115, v124
    v_fmac_f32 v125, v127, v114
    v_cvt_pk_bf16_f32 v142, v124, v125
    ds_write_addtid_b32 v142 offset:8432
    v_mul_f32 v132, v128, v118
    v_mul_f32 v133, v128, v119
    v_fma_f32 v132, -v129, v119, v132
    v_fmac_f32 v133, v129, v118
    v_cvt_pk_bf16_f32 v143, v132, v133
    ds_write_addtid_b32 v143 offset:2448
    v_mul_f32 v126, v124, v114
    v_mul_f32 v127, v124, v115
    v_fma_f32 v126, -v125, v115, v126
    v_fmac_f32 v127, v125, v114
    v_cvt_pk_bf16_f32 v140, v126, v127
    ds_write_addtid_b32 v140 offset:8704
    v_mul_f32 v134, v132, v118
    v_mul_f32 v135, v132, v119
    v_fma_f32 v134, -v133, v119, v134
    v_fmac_f32 v135, v133, v118
    v_cvt_pk_bf16_f32 v141, v134, v135
    ds_write_addtid_b32 v141 offset:2720
    v_mul_f32 v124, v126, v114
    v_mul_f32 v125, v126, v115
    v_fma_f32 v124, -v127, v115, v124
    v_fmac_f32 v125, v127, v114
    v_cvt_pk_bf16_f32 v142, v124, v125
    ds_write_addtid_b32 v142 offset:8976
    v_mul_f32 v132, v134, v118
    v_mul_f32 v133, v134, v119
    v_fma_f32 v132, -v135, v119, v132
    v_fmac_f32 v133, v135, v118
    v_cvt_pk_bf16_f32 v143, v132, v133
    ds_write_addtid_b32 v143 offset:2992
    v_mul_f32 v126, v124, v114
    v_mul_f32 v127, v124, v115
    v_fma_f32 v126, -v125, v115, v126
    v_fmac_f32 v127, v125, v114
    v_cvt_pk_bf16_f32 v140, v126, v127
    ds_write_addtid_b32 v140 offset:9248
    v_mul_f32 v130, v128, v116
    v_mul_f32 v131, v128, v117
    v_fma_f32 v130, -v129, v117, v130
    v_fmac_f32 v131, v129, v116
    v_cvt_pk_bf16_f32 v141, v130, v131
    ds_write_addtid_b32 v141 offset:3264
    v_mul_f32 v124, v126, v114
    v_mul_f32 v125, v126, v115
    v_fma_f32 v124, -v127, v115, v124
    v_fmac_f32 v125, v127, v114
    v_cvt_pk_bf16_f32 v142, v124, v125
    ds_write_addtid_b32 v142 offset:9520
    s_lshl_b32 s67, s74, 2
    s_add_u32 s67, s67, s66
    s_lshl_b32 s67, s67, 12
    s_add_u32 s71, s67, 5242880
    v_mul_f32 v132, v130, v120
    v_mul_f32 v133, v130, v121
    v_fma_f32 v132, -v131, v121, v132
    v_fmac_f32 v133, v131, v120
    v_cvt_pk_bf16_f32 v143, v132, v133
    ds_write_addtid_b32 v143 offset:3536
    v_mul_f32 v126, v124, v114
    v_mul_f32 v127, v124, v115
    v_fma_f32 v126, -v125, v115, v126
    v_fmac_f32 v127, v125, v114
    v_cvt_pk_bf16_f32 v140, v126, v127
    ds_write_addtid_b32 v140 offset:9792
    v_mul_f32 v128, v130, v116
    v_mul_f32 v129, v130, v117
    v_fma_f32 v128, -v131, v117, v128
    v_fmac_f32 v129, v131, v116
    v_cvt_pk_bf16_f32 v141, v128, v129
    ds_write_addtid_b32 v141 offset:3808
    v_mul_f32 v124, v126, v114
    v_mul_f32 v125, v126, v115
    v_fma_f32 v124, -v127, v115, v124
    v_fmac_f32 v125, v127, v114
    v_cvt_pk_bf16_f32 v142, v124, v125
    ds_write_addtid_b32 v142 offset:10064
    v_mul_f32 v132, v128, v120
    v_mul_f32 v133, v128, v121
    v_fma_f32 v132, -v129, v121, v132
    v_fmac_f32 v133, v129, v120
    v_cvt_pk_bf16_f32 v143, v132, v133
    ds_write_addtid_b32 v143 offset:4080
    v_mul_f32 v126, v124, v114
    v_mul_f32 v127, v124, v115
    v_fma_f32 v126, -v125, v115, v126
    v_fmac_f32 v127, v125, v114
    v_cvt_pk_bf16_f32 v140, v126, v127
    ds_write_addtid_b32 v140 offset:10336
    v_mul_f32 v130, v128, v116
    v_mul_f32 v131, v128, v117
    v_fma_f32 v130, -v129, v117, v130
    v_fmac_f32 v131, v129, v116
    v_cvt_pk_bf16_f32 v141, v130, v131
    ds_write_addtid_b32 v141 offset:4352
    v_mul_f32 v124, v126, v114
    v_mul_f32 v125, v126, v115
    v_fma_f32 v124, -v127, v115, v124
    v_fmac_f32 v125, v127, v114
    v_cvt_pk_bf16_f32 v142, v124, v125
    ds_write_addtid_b32 v142 offset:10608
    v_mul_f32 v128, v130, v116
    v_mul_f32 v129, v130, v117
    v_fma_f32 v128, -v131, v117, v128
    v_fmac_f32 v129, v131, v116
    v_cvt_pk_bf16_f32 v143, v128, v129
    ds_write_addtid_b32 v143 offset:4624
    v_mul_f32 v126, v124, v114
    v_mul_f32 v127, v124, v115
    v_fma_f32 v126, -v125, v115, v126
    v_fmac_f32 v127, v125, v114
    v_cvt_pk_bf16_f32 v140, v126, v127
    ds_write_addtid_b32 v140 offset:10880
    v_mul_f32 v130, v128, v116
    v_mul_f32 v131, v128, v117
    v_fma_f32 v130, -v129, v117, v130
    v_fmac_f32 v131, v129, v116
    v_cvt_pk_bf16_f32 v141, v130, v131
    ds_write_addtid_b32 v141 offset:4896
    v_mul_f32 v124, v126, v114
    v_mul_f32 v125, v126, v115
    v_fma_f32 v124, -v127, v115, v124
    v_fmac_f32 v125, v127, v114
    v_cvt_pk_bf16_f32 v142, v124, v125
    ds_write_addtid_b32 v142 offset:11152
    v_mul_f32 v128, v130, v116
    v_mul_f32 v129, v130, v117
    v_fma_f32 v128, -v131, v117, v128
    v_fmac_f32 v129, v131, v116
    v_cvt_pk_bf16_f32 v143, v128, v129
    ds_write_addtid_b32 v143 offset:5168
    v_mul_f32 v126, v124, v114
    v_mul_f32 v127, v124, v115
    v_fma_f32 v126, -v125, v115, v126
    v_fmac_f32 v127, v125, v114
    v_cvt_pk_bf16_f32 v140, v126, v127
    ds_write_addtid_b32 v140 offset:11424
    v_mul_f32 v130, v128, v116
    v_mul_f32 v131, v128, v117
    v_fma_f32 v130, -v129, v117, v130
    v_fmac_f32 v131, v129, v116
    v_cvt_pk_bf16_f32 v141, v130, v131
    ds_write_addtid_b32 v141 offset:5440
    v_mul_f32 v124, v126, v114
    v_mul_f32 v125, v126, v115
    v_fma_f32 v124, -v127, v115, v124
    v_fmac_f32 v125, v127, v114
    v_cvt_pk_bf16_f32 v142, v124, v125
    ds_write_addtid_b32 v142 offset:11696
    v_mul_f32 v126, v124, v114
    v_mul_f32 v127, v124, v115
    v_fma_f32 v126, -v125, v115, v126
    v_fmac_f32 v127, v125, v114
    v_cvt_pk_bf16_f32 v143, v126, v127
    ds_write_addtid_b32 v143 offset:11968
    v_mul_f32 v124, v126, v114
    v_mul_f32 v125, v126, v115
    v_fma_f32 v124, -v127, v115, v124
    v_fmac_f32 v125, v127, v114
    v_cvt_pk_bf16_f32 v140, v124, v125
    ds_write_addtid_b32 v140 offset:12240
    v_mul_f32 v126, v124, v114
    v_mul_f32 v127, v124, v115
    v_fma_f32 v126, -v125, v115, v126
    v_fmac_f32 v127, v125, v114
    v_cvt_pk_bf16_f32 v141, v126, v127
    ds_write_addtid_b32 v141 offset:12512
    v_mul_f32 v124, v126, v114
    v_mul_f32 v125, v126, v115
    v_fma_f32 v124, -v127, v115, v124
    v_fmac_f32 v125, v127, v114
    v_cvt_pk_bf16_f32 v142, v124, v125
    ds_write_addtid_b32 v142 offset:12784
    v_mul_f32 v126, v124, v114
    v_mul_f32 v127, v124, v115
    v_fma_f32 v126, -v125, v115, v126
    v_fmac_f32 v127, v125, v114
    v_cvt_pk_bf16_f32 v143, v126, v127
    ds_write_addtid_b32 v143 offset:13056
    v_mul_f32 v124, v126, v114
    v_mul_f32 v125, v126, v115
    v_fma_f32 v124, -v127, v115, v124
    v_fmac_f32 v125, v127, v114
    v_cvt_pk_bf16_f32 v140, v124, v125
    ds_write_addtid_b32 v140 offset:13328
    v_mul_f32 v126, v124, v114
    v_mul_f32 v127, v124, v115
    v_fma_f32 v126, -v125, v115, v126
    v_fmac_f32 v127, v125, v114
    v_cvt_pk_bf16_f32 v141, v126, v127
    ds_write_addtid_b32 v141 offset:13600
    v_mul_f32 v124, v126, v114
    v_mul_f32 v125, v126, v115
    v_fma_f32 v124, -v127, v115, v124
    v_fmac_f32 v125, v127, v114
    v_cvt_pk_bf16_f32 v142, v124, v125
    ds_write_addtid_b32 v142 offset:13872
    v_mul_f32 v126, v124, v114
    v_mul_f32 v127, v124, v115
    v_fma_f32 v126, -v125, v115, v126
    v_fmac_f32 v127, v125, v114
    v_cvt_pk_bf16_f32 v143, v126, v127
    ds_write_addtid_b32 v143 offset:14144
    s_waitcnt lgkmcnt(0)
    ds_read_b128 v[96:99], v60 offset:0
    ds_read_b128 v[100:103], v61 offset:5712
    ds_read_b128 v[104:107], v60 offset:32
    ds_read_b128 v[108:111], v61 offset:5744
    ds_read_b128 v[40:43], v60 offset:64
    ds_read_b128 v[44:47], v61 offset:5776
    ds_read_b128 v[48:51], v60 offset:96
    ds_read_b128 v[52:55], v61 offset:5808
    buffer_load_dwordx2 v[56:57], v157, s[48:51], 0 offen sc1
    s_waitcnt lgkmcnt(6)
    v_mfma_f32_32x32x16_bf16 v[64:79], v[96:99], v[100:103], v[64:79]
    ds_read_b128 v[96:99], v60 offset:128
    ds_read_b128 v[100:103], v61 offset:5840
    s_waitcnt lgkmcnt(6)
    v_mfma_f32_32x32x16_bf16 v[64:79], v[104:107], v[108:111], v[64:79]
    ds_read_b128 v[104:107], v60 offset:160
    ds_read_b128 v[108:111], v61 offset:5872
    s_waitcnt lgkmcnt(6)
    v_mfma_f32_32x32x16_bf16 v[64:79], v[40:43], v[44:47], v[64:79]
    ds_read_b128 v[40:43], v60 offset:192
    ds_read_b128 v[44:47], v61 offset:5904
    s_waitcnt lgkmcnt(6)
    v_mfma_f32_32x32x16_bf16 v[64:79], v[48:51], v[52:55], v[64:79]
    ds_read_b128 v[48:51], v60 offset:224
    ds_read_b128 v[52:55], v61 offset:5936
    s_waitcnt lgkmcnt(6)
    v_mfma_f32_32x32x16_bf16 v[80:95], v[96:99], v[100:103], v[80:95]
    s_waitcnt lgkmcnt(4)
    v_mfma_f32_32x32x16_bf16 v[80:95], v[104:107], v[108:111], v[80:95]
    s_waitcnt lgkmcnt(2)
    v_mfma_f32_32x32x16_bf16 v[80:95], v[40:43], v[44:47], v[80:95]
    s_waitcnt lgkmcnt(0)
    v_mfma_f32_32x32x16_bf16 v[80:95], v[48:51], v[52:55], v[80:95]
    s_nop 1
    ds_write_b128 v176, v[64:67] offset:0
    ds_write_b128 v176, v[68:71] offset:1024
    ds_write_b128 v176, v[72:75] offset:2048
    s_nop 6
    ds_write_b128 v176, v[80:83] offset:3072
    ds_write_b128 v176, v[84:87] offset:4096
    ds_write_b128 v176, v[88:91] offset:5120
    s_waitcnt vmcnt(0)
    v_cmp_ne_u64 vcc, s[46:47], v[56:57]
    s_mov_b64 s[64:65], vcc
    s_cmp_eq_u64 vcc, 0
    s_cbranch_scc0 L_ulate
    buffer_load_dwordx4 v[160:163], v3, s[48:51], s71 offen offset:0 sc1
    buffer_load_dwordx4 v[164:167], v3, s[48:51], s71 offen offset:1024 sc1
    buffer_load_dwordx4 v[168:171], v187, s[48:51], s71 offen offset:2048 sc1
    buffer_load_dwordx4 v[172:175], v187, s[48:51], s71 offen offset:3072 sc1
    s_branch L_nopoll2
L_ulate:
    buffer_load_dwordx2 v[56:57], v157, s[48:51], 0 offen sc1
L_nopoll2:
    s_lshl_b32 s68, s80, 13
    s_add_u32 s68, s68, 3145728
    s_add_u32 s69, s68, 4096
    s_cmp_eq_u32 s66, 3
    s_waitcnt lgkmcnt(0)
    s_barrier
    s_cbranch_scc1 L_nored
    ds_read_b128 v[64:67], v177 offset:0
    ds_read_b128 v[68:71], v177 offset:14416
    ds_read_b128 v[72:75], v177 offset:28832
    ds_read_b128 v[76:79], v177 offset:43248
    ds_read_b128 v[80:83], v177 offset:3072
    ds_read_b128 v[84:87], v177 offset:17488
    ds_read_b128 v[88:91], v177 offset:31904
    ds_read_b128 v[92:95], v177 offset:46320
    s_waitcnt lgkmcnt(4)
    v_add_f32 v64, v15, v64
    v_add_f32 v64, v64, v68
    v_add_f32 v72, v72, v76
    v_add_f32 v65, v65, v69
    v_add_f32 v73, v73, v77
    v_add_f32 v66, v66, v70
    v_add_f32 v74, v74, v78
    v_add_f32 v67, v67, v71
    v_add_f32 v75, v75, v79
    v_add_f32 v64, v64, v72
    v_add_f32 v65, v65, v73
    v_add_f32 v66, v66, v74
    v_add_f32 v67, v67, v75
    v_cvt_pk_bf16_f32 v64, v64, v65
    v_cvt_pk_bf16_f32 v65, v66, v67
    ds_write_b16 v153, v64 offset:0
    ds_write_b16_d16_hi v154, v64 offset:0
    ds_write_b16 v155, v65 offset:0
    ds_write_b16_d16_hi v156, v65 offset:0
    s_waitcnt lgkmcnt(4)
    v_add_f32 v80, v23, v80
    v_add_f32 v80, v80, v84
    v_add_f32 v88, v88, v92
    v_add_f32 v81, v81, v85
    v_add_f32 v89, v89, v93
    v_add_f32 v82, v82, v86
    v_add_f32 v90, v90, v94
    v_add_f32 v83, v83, v87
    v_add_f32 v91, v91, v95
    v_add_f32 v80, v80, v88
    v_add_f32 v81, v81, v89
    v_add_f32 v82, v82, v90
    v_add_f32 v83, v83, v91
    v_cvt_pk_bf16_f32 v80, v80, v81
    v_cvt_pk_bf16_f32 v81, v82, v83
    ds_write_b16 v153, v80 offset:1536
    ds_write_b16_d16_hi v154, v80 offset:1536
    ds_write_b16 v155, v81 offset:1536
    ds_write_b16_d16_hi v156, v81 offset:1536
L_nored:
    v_mov_b32 v40, 0
    v_mov_b32 v41, 0
    v_mov_b32 v42, 0
    v_mov_b32 v43, 0
    v_cmp_eq_u32 vcc, 255, v0
    s_waitcnt lgkmcnt(0)
    s_barrier
    ds_read_u16 v96, v144 offset:0
    ds_read_u16 v97, v145 offset:0
    ds_read_u16 v98, v146 offset:0
    ds_read_u16 v99, v147 offset:0
    ds_read_u16 v100, v148 offset:0
    ds_read_u16 v101, v149 offset:0
    ds_read_u16 v102, v150 offset:0
    ds_read_u16 v103, v151 offset:0
    ds_read_u16 v104, v152 offset:0
    ds_read_u16 v106, v144 offset:1536
    ds_read_u16 v107, v145 offset:1536
    ds_read_u16 v108, v146 offset:1536
    ds_read_u16 v109, v147 offset:1536
    ds_read_u16 v110, v148 offset:1536
    ds_read_u16 v111, v149 offset:1536
    ds_read_u16 v112, v150 offset:1536
    ds_read_u16 v113, v151 offset:1536
    ds_read_u16 v114, v152 offset:1536
    ds_write_b64 v178, v[40:41]
    ds_write_b128 v179, v[40:43]
    s_lshl_b32 s67, s75, 1
    s_cmp_lt_u32 s66, s67
    s_waitcnt lgkmcnt(11)
    v_lshl_or_b32 v64, v97, 16, v96
    v_lshl_or_b32 v65, v99, 16, v98
    v_lshl_or_b32 v66, v101, 16, v100
    v_lshl_or_b32 v67, v103, 16, v102
    buffer_store_dwordx4 v[64:67], v58, s[48:51], s68 offen sc1
    v_cndmask_b32 v104, v104, 0, vcc
    v_lshl_or_b32 v68, v98, 16, v97
    v_lshl_or_b32 v69, v100, 16, v99
    v_lshl_or_b32 v70, v102, 16, v101
    v_lshl_or_b32 v71, v104, 16, v103
    s_cbranch_scc1 L_skw0
    ds_write_b128 v180, v[64:67] offset:0
    ds_write2_b64 v181, v[64:65], v[66:67] offset0:0 offset1:1
    ds_write_b128 v180, v[68:71] offset:4160
    ds_write2_b64 v182, v[68:69], v[70:71] offset0:0 offset1:1
L_skw0:
    s_waitcnt lgkmcnt(2)
    v_lshl_or_b32 v72, v107, 16, v106
    v_lshl_or_b32 v73, v109, 16, v108
    v_lshl_or_b32 v74, v111, 16, v110
    v_lshl_or_b32 v75, v113, 16, v112
    buffer_store_dwordx4 v[72:75], v58, s[48:51], s69 offen sc1
    v_cndmask_b32 v114, v114, 0, vcc
    v_lshl_or_b32 v76, v108, 16, v107
    v_lshl_or_b32 v77, v110, 16, v109
    v_lshl_or_b32 v78, v112, 16, v111
    v_lshl_or_b32 v79, v114, 16, v113
    s_cbranch_scc1 L_skw1
    ds_write_b128 v180, v[72:75] offset:16640
    ds_write2_b64 v183, v[72:73], v[74:75] offset0:0 offset1:1
    ds_write_b128 v180, v[76:79] offset:20800
    ds_write2_b64 v184, v[76:77], v[78:79] offset0:0 offset1:1
L_skw1:
    s_cmp_eq_u64 s[64:65], 0
    s_cbranch_scc1 L_haveu
    s_waitcnt vmcnt(0)
    s_mov_b64 s[16:17], 0
Lp_16:
    v_cmp_ne_u64 vcc, s[46:47], v[56:57]
    s_cmp_eq_u64 vcc, 0
    s_cbranch_scc1 Lpo_17
    s_sub_u32 s15, s15, 1
    s_cbranch_scc1 L_end
    s_sub_u32 s18, vcc_lo, 1
    s_subb_u32 s19, vcc_hi, 0
    s_andn2_b64 s[18:19], vcc, s[18:19]
    s_cmp_eq_u64 vcc, s[16:17]
    s_mov_b64 s[16:17], vcc
    s_cselect_b64 exec, s[18:19], vcc
    s_sleep 1
    buffer_load_dwordx2 v[56:57], v157, s[48:51], 0 offen sc1
    s_mov_b64 exec, -1
    s_waitcnt vmcnt(0)
    s_branch Lp_16
Lpo_17:
    s_mov_b64 exec, -1
    buffer_load_dwordx4 v[160:163], v3, s[48:51], s71 offen offset:0 sc1
    buffer_load_dwordx4 v[164:167], v3, s[48:51], s71 offen offset:1024 sc1
    buffer_load_dwordx4 v[168:171], v187, s[48:51], s71 offen offset:2048 sc1
    buffer_load_dwordx4 v[172:175], v187, s[48:51], s71 offen offset:3072 sc1
L_haveu:
    s_waitcnt vmcnt(0)
    s_mov_b64 exec, 1
    buffer_store_dwordx2 v[190:191], off, s[48:51], s81 sc1
    s_mov_b64 exec, -1
    ds_write_b128 v185, v[160:163] offset:16
    v_mov_b32 v80, 0
    v_mov_b32 v81, v160
    v_mov_b32 v82, v161
    v_mov_b32 v83, v162
    v_mov_b32_dpp v80, v163 wave_shr:1 row_mask:0xf bank_mask:0xf
    ds_write_b128 v185, v[80:83] offset:4144
    ds_write_b128 v185, v[164:167] offset:1040
    v_readlane_b32 s67, v163, 63
    v_mov_b32 v85, v164
    v_mov_b32 v86, v165
    v_mov_b32 v87, v166
    v_mov_b32 v84, s67
    s_nop 1
    v_mov_b32_dpp v84, v167 wave_shr:1 row_mask:0xf bank_mask:0xf
    ds_write_b128 v185, v[84:87] offset:5168
    s_cmp_eq_u32 s75, 1
    s_cbranch_scc1 L_sku
    ds_write_b128 v185, v[168:171] offset:2064
    v_readlane_b32 s67, v167, 63
    v_mov_b32 v89, v168
    v_mov_b32 v90, v169
    v_mov_b32 v91, v170
    v_mov_b32 v88, s67
    s_nop 1
    v_mov_b32_dpp v88, v171 wave_shr:1 row_mask:0xf bank_mask:0xf
    ds_write_b128 v185, v[88:91] offset:6192
    ds_write_b128 v185, v[172:175] offset:3088
    v_readlane_b32 s67, v171, 63
    v_mov_b32 v93, v172
    v_mov_b32 v94, v173
    v_mov_b32 v95, v174
    v_mov_b32 v92, s67
    s_nop 1
    v_mov_b32_dpp v92, v175 wave_shr:1 row_mask:0xf bank_mask:0xf
    ds_write_b128 v185, v[92:95] offset:7216
L_sku:
    s_setprio 1
L_skp2:
    v_mov_b32 v12, v158
    v_mov_b32 v32, v59
    s_lshr_b32 s67, s66, 1
    s_lshl_b32 s69, s75, 1
    s_add_u32 s72, s67, s69
    s_mul_i32 s76, s72, 8256
    s_and_b32 s68, s66, 1
    s_lshl_b32 s69, s68, 11
    s_add_u32 s70, s76, 33280
    s_add_u32 s71, s70, s69
    v_add_u32 v9, s71, v3
    s_add_u32 s70, s70, 2048
    s_sub_u32 s70, s70, s69
    v_add_u32 v10, s70, v3
    v_bfe_u32 v11, v2, 1, 3
    v_lshlrev_b32 v11, 6, v11
    v_lshrrev_b32 v13, 4, v2
    v_lshl_add_u32 v11, v13, 4, v11
    v_and_b32 v13, 1, v2
    v_lshl_add_u32 v11, v13, 2, v11
    s_lshl_b32 s71, s68, 10
    s_add_u32 s71, s71, 66304
    v_add_u32 v11, s71, v11
    s_xor_b32 s77, s80, 1
    s_lshl_b32 s77, s77, 13
    s_lshl_b32 s70, s66, 11
    s_add_u32 s77, s77, s70
    s_add_u32 s77, s77, 3145728
    s_mul_i32 s81, s67, 16640
    s_add_u32 s81, s81, s69
    s_sub_u32 s73, s68, 1
    s_and_b32 s70, s73, s75
    s_mul_i32 s71, s70, 4096
    s_mul_i32 s70, s70, 0x7fff0000
    v_add_u32 v38, s70, v3
    v_mov_b32 v39, 0x7fff0000
    v_cmp_le_u32 vcc, s71, v3
    s_nop 1
    v_cndmask_b32 v39, v39, v3, vcc
    s_mov_b32 s79, 0
    v_mov_b32 v5, v188
    v_add_u32 v6, s76, v189
    v_add_u32 v8, s76, v32
    v_max_i32 v7, v8, v6
    s_mov_b32 s78, 0
    buffer_load_dwordx2 v[14:15], v12, s[48:51], 0 offen sc1
    s_cmp_eq_u32 s75, 1
    s_waitcnt lgkmcnt(0)
    s_barrier
    s_cbranch_scc1 L_cv1pre
L_cv0pre:
    ds_read_b128 v[112:115], v7 offset:0
    ds_read_b128 v[48:51], v5 offset:3584
    ds_read_b128 v[116:119], v6 offset:512
    ds_read_b128 v[52:55], v5 offset:3072
    ds_read_b128 v[120:123], v6 offset:1024
    ds_read_b128 v[56:59], v5 offset:2560
    ds_read_b128 v[124:127], v6 offset:1536
    ds_read_b128 v[60:63], v5 offset:2048
    ds_read_b128 v[128:131], v6 offset:2048
    ds_read_b128 v[64:67], v5 offset:1536
    ds_read_b128 v[132:135], v6 offset:2560
    ds_read_b128 v[68:71], v5 offset:1024
    ds_read_b128 v[136:139], v6 offset:3072
    ds_read_b128 v[72:75], v5 offset:512
    ds_read_b128 v[140:143], v6 offset:3584
    ds_read_b128 v[76:79], v5 offset:0
    v_subrev_u32 v5, 64, v5
    v_subrev_u32 v6, 64, v6
    v_max_i32 v7, v8, v6
    v_mov_b32 v16, 0
    v_mov_b32 v17, 0
    v_mov_b32 v18, 0
    v_mov_b32 v19, 0
    v_mov_b32 v20, 0
    v_mov_b32 v21, 0
    v_mov_b32 v22, 0
    v_mov_b32 v23, 0
    v_mov_b32 v24, 0
    v_mov_b32 v25, 0
    v_mov_b32 v26, 0
    v_mov_b32 v27, 0
    v_mov_b32 v28, 0
    v_mov_b32 v29, 0
    v_mov_b32 v30, 0
    v_mov_b32 v31, 0
L_cv0:
    s_waitcnt lgkmcnt(10)
    v_mfma_f32_16x16x32_bf16 v[16:19], v[56:59], v[120:123], v[16:19]
    s_waitcnt lgkmcnt(8)
    v_mfma_f32_16x16x32_bf16 v[16:19], v[52:55], v[124:127], v[16:19]
    v_mfma_f32_16x16x32_bf16 v[16:19], v[60:63], v[116:119], v[16:19]
    v_mfma_f32_16x16x32_bf16 v[20:23], v[56:59], v[124:127], v[20:23]
    v_mfma_f32_16x16x32_bf16 v[20:23], v[60:63], v[120:123], v[20:23]
    ds_read_b128 v[144:147], v7 offset:0
    v_mfma_f32_16x16x32_bf16 v[24:27], v[60:63], v[124:127], v[24:27]
    ds_read_b128 v[80:83], v5 offset:3584
    s_waitcnt lgkmcnt(8)
    v_mfma_f32_16x16x32_bf16 v[16:19], v[48:51], v[128:131], v[16:19]
    ds_read_b128 v[148:151], v6 offset:512
    v_mfma_f32_16x16x32_bf16 v[16:19], v[64:67], v[112:115], v[16:19]
    ds_read_b128 v[84:87], v5 offset:3072
    v_mfma_f32_16x16x32_bf16 v[20:23], v[52:55], v[128:131], v[20:23]
    ds_read_b128 v[152:155], v6 offset:1024
    v_mfma_f32_16x16x32_bf16 v[20:23], v[64:67], v[116:119], v[20:23]
    ds_read_b128 v[88:91], v5 offset:2560
    v_mfma_f32_16x16x32_bf16 v[24:27], v[56:59], v[128:131], v[24:27]
    ds_read_b128 v[156:159], v6 offset:1536
    v_mfma_f32_16x16x32_bf16 v[24:27], v[64:67], v[120:123], v[24:27]
    ds_read_b128 v[92:95], v5 offset:2048
    v_mfma_f32_16x16x32_bf16 v[28:31], v[60:63], v[128:131], v[28:31]
    ds_read_b128 v[160:163], v6 offset:2048
    v_mfma_f32_16x16x32_bf16 v[28:31], v[64:67], v[124:127], v[28:31]
    ds_read_b128 v[96:99], v5 offset:1536
    s_waitcnt lgkmcnt(14)
    v_mfma_f32_16x16x32_bf16 v[20:23], v[48:51], v[132:135], v[20:23]
    ds_read_b128 v[164:167], v6 offset:2560
    v_mfma_f32_16x16x32_bf16 v[20:23], v[68:71], v[112:115], v[20:23]
    ds_read_b128 v[100:103], v5 offset:1024
    v_mfma_f32_16x16x32_bf16 v[24:27], v[52:55], v[132:135], v[24:27]
    ds_read_b128 v[168:171], v6 offset:3072
    v_mfma_f32_16x16x32_bf16 v[24:27], v[68:71], v[116:119], v[24:27]
    ds_read_b128 v[104:107], v5 offset:512
    v_mfma_f32_16x16x32_bf16 v[28:31], v[56:59], v[132:135], v[28:31]
    ds_read_b128 v[172:175], v6 offset:3584
    v_mfma_f32_16x16x32_bf16 v[28:31], v[68:71], v[120:123], v[28:31]
    ds_read_b128 v[108:111], v5 offset:0
    s_waitcnt lgkmcnt(15)
    v_mfma_f32_16x16x32_bf16 v[24:27], v[48:51], v[136:139], v[24:27]
    v_subrev_u32 v5, 64, v5
    v_mfma_f32_16x16x32_bf16 v[24:27], v[72:75], v[112:115], v[24:27]
    v_subrev_u32 v6, 64, v6
    v_mfma_f32_16x16x32_bf16 v[28:31], v[52:55], v[136:139], v[28:31]
    v_max_i32 v7, v8, v6
    v_mfma_f32_16x16x32_bf16 v[28:31], v[72:75], v[116:119], v[28:31]
    s_waitcnt lgkmcnt(15)
    v_mfma_f32_16x16x32_bf16 v[28:31], v[48:51], v[140:143], v[28:31]
    v_mfma_f32_16x16x32_bf16 v[28:31], v[76:79], v[112:115], v[28:31]
    s_waitcnt lgkmcnt(10)
    v_mfma_f32_16x16x32_bf16 v[16:19], v[88:91], v[152:155], v[16:19]
    s_waitcnt lgkmcnt(8)
    v_mfma_f32_16x16x32_bf16 v[16:19], v[84:87], v[156:159], v[16:19]
    v_mfma_f32_16x16x32_bf16 v[16:19], v[92:95], v[148:151], v[16:19]
    v_mfma_f32_16x16x32_bf16 v[20:23], v[88:91], v[156:159], v[20:23]
    v_mfma_f32_16x16x32_bf16 v[20:23], v[92:95], v[152:155], v[20:23]
    ds_read_b128 v[112:115], v7 offset:0
    v_mfma_f32_16x16x32_bf16 v[24:27], v[92:95], v[156:159], v[24:27]
    ds_read_b128 v[48:51], v5 offset:3584
    s_waitcnt lgkmcnt(8)
    v_mfma_f32_16x16x32_bf16 v[16:19], v[80:83], v[160:163], v[16:19]
    ds_read_b128 v[116:119], v6 offset:512
    v_mfma_f32_16x16x32_bf16 v[16:19], v[96:99], v[144:147], v[16:19]
    ds_read_b128 v[52:55], v5 offset:3072
    v_mfma_f32_16x16x32_bf16 v[20:23], v[84:87], v[160:163], v[20:23]
    ds_read_b128 v[120:123], v6 offset:1024
    v_mfma_f32_16x16x32_bf16 v[20:23], v[96:99], v[148:151], v[20:23]
    ds_read_b128 v[56:59], v5 offset:2560
    v_mfma_f32_16x16x32_bf16 v[24:27], v[88:91], v[160:163], v[24:27]
    ds_read_b128 v[124:127], v6 offset:1536
    v_mfma_f32_16x16x32_bf16 v[24:27], v[96:99], v[152:155], v[24:27]
    ds_read_b128 v[60:63], v5 offset:2048
    v_mfma_f32_16x16x32_bf16 v[28:31], v[92:95], v[160:163], v[28:31]
    ds_read_b128 v[128:131], v6 offset:2048
    v_mfma_f32_16x16x32_bf16 v[28:31], v[96:99], v[156:159], v[28:31]
    ds_read_b128 v[64:67], v5 offset:1536
    s_waitcnt lgkmcnt(14)
    v_mfma_f32_16x16x32_bf16 v[20:23], v[80:83], v[164:167], v[20:23]
    ds_read_b128 v[132:135], v6 offset:2560
    v_mfma_f32_16x16x32_bf16 v[20:23], v[100:103], v[144:147], v[20:23]
    ds_read_b128 v[68:71], v5 offset:1024
    v_mfma_f32_16x16x32_bf16 v[24:27], v[84:87], v[164:167], v[24:27]
    ds_read_b128 v[136:139], v6 offset:3072
    v_mfma_f32_16x16x32_bf16 v[24:27], v[100:103], v[148:151], v[24:27]
    ds_read_b128 v[72:75], v5 offset:512
    v_mfma_f32_16x16x32_bf16 v[28:31], v[88:91], v[164:167], v[28:31]
    ds_read_b128 v[140:143], v6 offset:3584
    v_mfma_f32_16x16x32_bf16 v[28:31], v[100:103], v[152:155], v[28:31]
    ds_read_b128 v[76:79], v5 offset:0
    s_waitcnt lgkmcnt(15)
    v_mfma_f32_16x16x32_bf16 v[24:27], v[80:83], v[168:171], v[24:27]
    v_subrev_u32 v5, 64, v5
    v_mfma_f32_16x16x32_bf16 v[24:27], v[104:107], v[144:147], v[24:27]
    v_subrev_u32 v6, 64, v6
    v_mfma_f32_16x16x32_bf16 v[28:31], v[84:87], v[168:171], v[28:31]
    v_max_i32 v7, v8, v6
    v_mfma_f32_16x16x32_bf16 v[28:31], v[104:107], v[148:151], v[28:31]
    s_waitcnt lgkmcnt(15)
    v_mfma_f32_16x16x32_bf16 v[28:31], v[80:83], v[172:175], v[28:31]
    v_mfma_f32_16x16x32_bf16 v[28:31], v[108:111], v[144:147], v[28:31]
    s_add_u32 s78, s78, 1
    s_cmp_eq_u32 s78, 2
    s_cbranch_scc1 L_cvdone
    s_cmp_eq_u32 s79, 1
    s_cbranch_scc1 L_cv0
    s_waitcnt vmcnt(0)
    v_cmp_ne_u64 vcc, s[46:47], v[14:15]
    s_mov_b64 s[64:65], vcc
    s_cmp_eq_u64 vcc, 0
    s_cbranch_scc0 L_late0
    buffer_load_dwordx4 v[176:179], v38, s[48:51], s77 offen sc1
    buffer_load_dwordx4 v[182:185], v39, s[48:51], s77 offen offset:1024 sc1
    buffer_load_dword v187, off, s[48:51], s77 offset:2048 sc1
    s_branch L_cv0
L_late0:
    buffer_load_dwordx2 v[14:15], v12, s[48:51], 0 offen sc1
    s_branch L_cv0
L_cv1pre:
    ds_read_b128 v[112:115], v7 offset:0
    ds_read_b128 v[48:51], v5 offset:3584
    ds_read_b128 v[116:119], v6 offset:512
    ds_read_b128 v[52:55], v5 offset:3072
    ds_read_b128 v[120:123], v6 offset:1024
    ds_read_b128 v[56:59], v5 offset:2560
    ds_read_b128 v[124:127], v6 offset:1536
    ds_read_b128 v[60:63], v5 offset:2048
    v_subrev_u32 v5, 64, v5
    v_subrev_u32 v6, 64, v6
    v_max_i32 v7, v8, v6
    v_mov_b32 v16, 0
    v_mov_b32 v17, 0
    v_mov_b32 v18, 0
    v_mov_b32 v19, 0
    v_mov_b32 v20, 0
    v_mov_b32 v21, 0
    v_mov_b32 v22, 0
    v_mov_b32 v23, 0
    v_mov_b32 v24, 0
    v_mov_b32 v25, 0
    v_mov_b32 v26, 0
    v_mov_b32 v27, 0
    v_mov_b32 v28, 0
    v_mov_b32 v29, 0
    v_mov_b32 v30, 0
    v_mov_b32 v31, 0
L_cv1:
    s_waitcnt lgkmcnt(6)
    v_mfma_f32_16x16x32_bf16 v[16:19], v[48:51], v[112:115], v[16:19]
    ds_read_b128 v[144:147], v7 offset:0
    s_waitcnt lgkmcnt(5)
    v_mfma_f32_16x16x32_bf16 v[20:23], v[48:51], v[116:119], v[20:23]
    ds_read_b128 v[80:83], v5 offset:3584
    v_mfma_f32_16x16x32_bf16 v[20:23], v[52:55], v[112:115], v[20:23]
    ds_read_b128 v[148:151], v6 offset:512
    v_mfma_f32_16x16x32_bf16 v[24:27], v[52:55], v[116:119], v[24:27]
    ds_read_b128 v[84:87], v5 offset:3072
    s_waitcnt lgkmcnt(6)
    v_mfma_f32_16x16x32_bf16 v[24:27], v[48:51], v[120:123], v[24:27]
    ds_read_b128 v[152:155], v6 offset:1024
    v_mfma_f32_16x16x32_bf16 v[24:27], v[56:59], v[112:115], v[24:27]
    ds_read_b128 v[88:91], v5 offset:2560
    v_mfma_f32_16x16x32_bf16 v[28:31], v[52:55], v[120:123], v[28:31]
    ds_read_b128 v[156:159], v6 offset:1536
    v_mfma_f32_16x16x32_bf16 v[28:31], v[56:59], v[116:119], v[28:31]
    ds_read_b128 v[92:95], v5 offset:2048
    s_waitcnt lgkmcnt(8)
    v_mfma_f32_16x16x32_bf16 v[28:31], v[48:51], v[124:127], v[28:31]
    v_subrev_u32 v5, 64, v5
    v_mfma_f32_16x16x32_bf16 v[28:31], v[60:63], v[112:115], v[28:31]
    v_subrev_u32 v6, 64, v6
    v_max_i32 v7, v8, v6
    s_waitcnt lgkmcnt(6)
    v_mfma_f32_16x16x32_bf16 v[16:19], v[80:83], v[144:147], v[16:19]
    ds_read_b128 v[112:115], v7 offset:0
    s_waitcnt lgkmcnt(5)
    v_mfma_f32_16x16x32_bf16 v[20:23], v[80:83], v[148:151], v[20:23]
    ds_read_b128 v[48:51], v5 offset:3584
    v_mfma_f32_16x16x32_bf16 v[20:23], v[84:87], v[144:147], v[20:23]
    ds_read_b128 v[116:119], v6 offset:512
    v_mfma_f32_16x16x32_bf16 v[24:27], v[84:87], v[148:151], v[24:27]
    ds_read_b128 v[52:55], v5 offset:3072
    s_waitcnt lgkmcnt(6)
    v_mfma_f32_16x16x32_bf16 v[24:27], v[80:83], v[152:155], v[24:27]
    ds_read_b128 v[120:123], v6 offset:1024
    v_mfma_f32_16x16x32_bf16 v[24:27], v[88:91], v[144:147], v[24:27]
    ds_read_b128 v[56:59], v5 offset:2560
    v_mfma_f32_16x16x32_bf16 v[28:31], v[84:87], v[152:155], v[28:31]
    ds_read_b128 v[124:127], v6 offset:1536
    v_mfma_f32_16x16x32_bf16 v[28:31], v[88:91], v[148:151], v[28:31]
    ds_read_b128 v[60:63], v5 offset:2048
    s_waitcnt lgkmcnt(8)
    v_mfma_f32_16x16x32_bf16 v[28:31], v[80:83], v[156:159], v[28:31]
    v_subrev_u32 v5, 64, v5
    v_mfma_f32_16x16x32_bf16 v[28:31], v[92:95], v[144:147], v[28:31]
    v_subrev_u32 v6, 64, v6
    v_max_i32 v7, v8, v6
    s_add_u32 s78, s78, 1
    s_cmp_eq_u32 s78, 2
    s_cbranch_scc1 L_cvdone
    s_cmp_eq_u32 s79, 1
    s_cbranch_scc1 L_cv1
    s_waitcnt vmcnt(0)
    v_cmp_ne_u64 vcc, s[46:47], v[14:15]
    s_mov_b64 s[64:65], vcc
    s_cmp_eq_u64 vcc, 0
    s_cbranch_scc0 L_late1
    buffer_load_dwordx4 v[176:179], v38, s[48:51], s77 offen sc1
    buffer_load_dwordx4 v[182:185], v39, s[48:51], s77 offen offset:1024 sc1
    buffer_load_dword v187, off, s[48:51], s77 offset:2048 sc1
    s_branch L_cv1
L_late1:
    buffer_load_dwordx2 v[14:15], v12, s[48:51], 0 offen sc1
    s_branch L_cv1
L_cvdone:
    s_cmp_eq_u32 s79, 1
    s_cbranch_scc1 L_ph1
    s_cmp_eq_u64 s[64:65], 0
    s_cbranch_scc1 L_havek
    s_waitcnt vmcnt(0)
    s_mov_b64 s[16:17], 0
Lp_18:
    v_cmp_ne_u64 vcc, s[46:47], v[14:15]
    s_cmp_eq_u64 vcc, 0
    s_cbranch_scc1 Lpo_19
    s_sub_u32 s15, s15, 1
    s_cbranch_scc1 L_end
    s_sub_u32 s18, vcc_lo, 1
    s_subb_u32 s19, vcc_hi, 0
    s_andn2_b64 s[18:19], vcc, s[18:19]
    s_cmp_eq_u64 vcc, s[16:17]
    s_mov_b64 s[16:17], vcc
    s_cselect_b64 exec, s[18:19], vcc
    s_sleep 1
    buffer_load_dwordx2 v[14:15], v12, s[48:51], 0 offen sc1
    s_mov_b64 exec, -1
    s_waitcnt vmcnt(0)
    s_branch Lp_18
Lpo_19:
    s_mov_b64 exec, -1
    buffer_load_dwordx4 v[176:179], v38, s[48:51], s77 offen sc1
    buffer_load_dwordx4 v[182:185], v39, s[48:51], s77 offen offset:1024 sc1
    buffer_load_dword v187, off, s[48:51], s77 offset:2048 sc1
L_havek:
    s_waitcnt lgkmcnt(0)
    s_barrier
L_ph1:
    s_mul_i32 s67, s72, 2112
    v_add_u32 v33, s67, v11
    s_bitcmp1_b32 s66, 0
    s_cbranch_scc1 L_xodd
    ds_write_b128 v9, v[24:27] offset:0
    ds_write_b128 v9, v[28:31] offset:1024
    s_cmp_eq_u32 s79, 1
    s_cbranch_scc1 L_nok16
    s_cmp_eq_u32 s75, 1
    s_cbranch_scc1 L_nok16
    v_add_u32 v13, s81, v3
    v_add_u32 v14, 8312, v13
    v_add_u32 v15, 12472, v13
    s_waitcnt vmcnt(0)
    v_and_b32 v186, s73, v187
    v_readlane_b32 s67, v182, 0
    s_nop 0
    v_mov_b32_dpp v186, v182 wave_shl:1 row_mask:0xf bank_mask:0xf
    v_mov_b32 v180, s67
    s_nop 1
    v_mov_b32_dpp v180, v176 wave_shl:1 row_mask:0xf bank_mask:0xf
    v_alignbit_b32 v52, v183, v182, 16
    v_alignbit_b32 v53, v184, v183, 16
    v_alignbit_b32 v54, v185, v184, 16
    v_alignbit_b32 v55, v186, v185, 16
    ds_write_b128 v13, v[182:185] offset:1024
    ds_write2_b64 v14, v[182:183], v[184:185] offset0:128 offset1:129
    ds_write_b128 v13, v[52:55] offset:5184
    ds_write2_b64 v15, v[52:53], v[54:55] offset0:128 offset1:129
    v_alignbit_b32 v48, v177, v176, 16
    v_alignbit_b32 v49, v178, v177, 16
    v_alignbit_b32 v50, v179, v178, 16
    v_alignbit_b32 v51, v180, v179, 16
    ds_write_b128 v13, v[176:179] offset:0
    ds_write2_b64 v14, v[176:177], v[178:179] offset0:0 offset1:1
    ds_write_b128 v13, v[48:51] offset:4160
    ds_write2_b64 v15, v[48:49], v[50:51] offset0:0 offset1:1
L_nok16:
    s_waitcnt lgkmcnt(0)
    s_barrier
    ds_read_b128 v[24:27], v10 offset:0
    ds_read_b128 v[28:31], v10 offset:1024
    s_waitcnt lgkmcnt(1)
    v_add_f32 v16, v16, v24
    v_add_f32 v17, v17, v25
    v_add_f32 v18, v18, v26
    v_add_f32 v19, v19, v27
    v_cvt_pk_bf16_f32 v34, v16, v17
    v_cvt_pk_bf16_f32 v35, v18, v19
    ds_write2_b32 v33, v34, v35 offset0:0 offset1:2
    s_waitcnt lgkmcnt(1)
    v_add_f32 v20, v20, v28
    v_add_f32 v21, v21, v29
    v_add_f32 v22, v22, v30
    v_add_f32 v23, v23, v31
    v_cvt_pk_bf16_f32 v36, v20, v21
    v_cvt_pk_bf16_f32 v37, v22, v23
    ds_write2_b32 v33, v36, v37 offset0:128 offset1:130
    s_branch L_xdone
L_xodd:
    ds_write_b128 v9, v[16:19] offset:0
    ds_write_b128 v9, v[20:23] offset:1024
    s_cmp_eq_u32 s79, 1
    s_cbranch_scc1 L_nok24
    v_add_u32 v13, s81, v3
    v_add_u32 v14, 8312, v13
    v_add_u32 v15, 12472, v13
    s_waitcnt vmcnt(0)
    v_and_b32 v186, s73, v187
    v_readlane_b32 s67, v182, 0
    s_nop 0
    v_mov_b32_dpp v186, v182 wave_shl:1 row_mask:0xf bank_mask:0xf
    v_mov_b32 v180, s67
    s_nop 1
    v_mov_b32_dpp v180, v176 wave_shl:1 row_mask:0xf bank_mask:0xf
    v_alignbit_b32 v52, v183, v182, 16
    v_alignbit_b32 v53, v184, v183, 16
    v_alignbit_b32 v54, v185, v184, 16
    v_alignbit_b32 v55, v186, v185, 16
    ds_write_b128 v13, v[182:185] offset:1024
    ds_write2_b64 v14, v[182:183], v[184:185] offset0:128 offset1:129
    ds_write_b128 v13, v[52:55] offset:5184
    ds_write2_b64 v15, v[52:53], v[54:55] offset0:128 offset1:129
    v_alignbit_b32 v48, v177, v176, 16
    v_alignbit_b32 v49, v178, v177, 16
    v_alignbit_b32 v50, v179, v178, 16
    v_alignbit_b32 v51, v180, v179, 16
    ds_write_b128 v13, v[176:179] offset:0
    ds_write2_b64 v14, v[176:177], v[178:179] offset0:0 offset1:1
    ds_write_b128 v13, v[48:51] offset:4160
    ds_write2_b64 v15, v[48:49], v[50:51] offset0:0 offset1:1
L_nok24:
    s_waitcnt lgkmcnt(0)
    s_barrier
    ds_read_b128 v[16:19], v10 offset:0
    ds_read_b128 v[20:23], v10 offset:1024
    s_waitcnt lgkmcnt(1)
    v_add_f32 v24, v24, v16
    v_add_f32 v25, v25, v17
    v_add_f32 v26, v26, v18
    v_add_f32 v27, v27, v19
    v_cvt_pk_bf16_f32 v34, v24, v25
    v_cvt_pk_bf16_f32 v35, v26, v27
    ds_write2_b32 v33, v34, v35 offset0:0 offset1:2
    s_waitcnt lgkmcnt(1)
    v_add_f32 v28, v28, v20
    v_add_f32 v29, v29, v21
    v_add_f32 v30, v30, v22
    v_add_f32 v31, v31, v23
    v_cvt_pk_bf16_f32 v36, v28, v29
    v_cvt_pk_bf16_f32 v37, v30, v31
    ds_write2_b32 v33, v36, v37 offset0:128 offset1:130
L_xdone:
    s_cmp_eq_u32 s79, 1
    s_cbranch_scc1 L_cvend
    s_mov_b32 s79, 1
    s_xor_b32 s72, s72, 2
    s_mul_i32 s76, s72, 8256
    v_mov_b32 v5, v188
    v_add_u32 v6, s76, v189
    v_add_u32 v8, s76, v32
    v_max_i32 v7, v8, v6
    s_mov_b32 s78, 0
    s_cmp_eq_u32 s75, 1
    s_cbranch_scc1 L_cv1pre
    s_branch L_cv0pre
L_cvend:
    v_bfe_u32 v10, v2, 2, 2
    v_mul_u32_u24 v10, 2112, v10
    v_lshrrev_b32 v8, 4, v2
    v_lshl_add_u32 v10, v8, 5, v10
    v_and_b32 v8, 3, v2
    v_lshl_add_u32 v10, v8, 3, v10
    s_lshl_b32 s67, s66, 9
    s_add_u32 s67, s67, 66304
    v_add_u32 v10, s67, v10
    v_mul_u32_u24 v11, 1792, v2
    s_lshl_b32 s69, s75, 4
    s_lshl_b32 s70, s66, 2
    s_add_u32 s69, s69, s70
    s_lshr_b32 s69, 839939668, s69
    s_and_b32 s69, s69, 15
    s_mul_i32 s69, s69, 458752
    s_lshl_b32 s70, s74, 3
    s_add_u32 s69, s69, s70
    s_waitcnt lgkmcnt(0)
    s_barrier
    ds_read_b64_tr_b16 v[48:49], v10 offset:0
    ds_read_b64_tr_b16 v[50:51], v10 offset:128
    ds_read_b64_tr_b16 v[52:53], v10 offset:256
    ds_read_b64_tr_b16 v[54:55], v10 offset:384
    s_waitcnt lgkmcnt(3)
    buffer_store_dwordx2 v[48:49], v11, s[60:63], s69 offen
    s_add_u32 s69, s69, 114688
    s_waitcnt lgkmcnt(2)
    buffer_store_dwordx2 v[50:51], v11, s[60:63], s69 offen
    s_add_u32 s69, s69, 114688
    s_waitcnt lgkmcnt(1)
    buffer_store_dwordx2 v[52:53], v11, s[60:63], s69 offen
    s_add_u32 s69, s69, 114688
    s_waitcnt lgkmcnt(0)
    buffer_store_dwordx2 v[54:55], v11, s[60:63], s69 offen
L_send:
    s_endpgm
L_aux:
    s_cmp_ge_u32 s73, 5
    s_cbranch_scc1 L_end
    s_cmp_lg_u32 s73, 0
    s_cbranch_scc1 L_zkv
    s_cmp_lg_u32 s66, 0
    s_cbranch_scc1 L_end
    s_memrealtime s[46:47]
    s_waitcnt lgkmcnt(0)
    s_or_b32 s46, s46, 1
    v_mov_b32 v8, s46
    v_mov_b32 v9, s47
    s_mov_b64 exec, 1
    global_store_dwordx2 v4, v[8:9], s[42:43] sc1
    s_endpgm
L_zkv:
    v_mov_b32 v8, 0
    v_mov_b32 v9, 0
    v_mov_b32 v10, 0
    v_mov_b32 v11, 0
    v_lshlrev_b32 v5, 4, v0
    s_lshl_b32 s67, s73, 7
    s_add_u32 s67, s67, 2473856
    s_lshl_b32 s68, s73, 14
    s_add_u32 s68, s68, 2080768
    s_waitcnt lgkmcnt(0)
    s_mov_b32 s48, s44
    s_mov_b32 s49, s45
    s_mov_b32 s50, 7340032
    s_mov_b32 s51, 0x20000
    buffer_store_dwordx4 v[8:11], v5, s[48:51], s68 offen sc1
    s_add_u32 s68, s68, 4096
    buffer_store_dwordx4 v[8:11], v5, s[48:51], s68 offen sc1
    s_add_u32 s68, s68, 4096
    buffer_store_dwordx4 v[8:11], v5, s[48:51], s68 offen sc1
    s_add_u32 s68, s68, 4096
    buffer_store_dwordx4 v[8:11], v5, s[48:51], s68 offen sc1
    s_memrealtime s[12:13]
    global_load_dwordx2 v[190:191], v4, s[42:43] sc1
    s_waitcnt vmcnt(0)
    s_waitcnt lgkmcnt(0)
    s_mov_b32 s13, 200
Li_20:
    v_readfirstlane_b32 s46, v190
    v_readfirstlane_b32 s47, v191
    s_sub_u32 s3, s46, s12
    s_cmp_eq_u32 s46, 0
    s_cbranch_scc1 Lir_22
    s_cmp_gt_i32 s3, -900
    s_cbranch_scc1 Lio_21
    s_sub_u32 s13, s13, 1
    s_cbranch_scc1 Lio_21
Lir_22:
    s_sub_u32 s15, s15, 1
    s_cbranch_scc1 L_end
    s_sleep 1
    global_load_dwordx2 v[190:191], v4, s[42:43] sc1
    s_waitcnt vmcnt(0)
    s_branch Li_20
Lio_21:
    s_barrier
    s_cmp_lg_u32 s66, 0
    s_cbranch_scc1 L_send
    s_mov_b64 exec, 1
    buffer_store_dwordx2 v[190:191], off, s[48:51], s67 sc1
    s_mov_b64 exec, -1
    s_branch L_send
L_end:
    s_endpgm
.section .rodata,"a"
.p2align 6
.amdhsa_kernel concat_heads__ssm_conv_s4__linear_attn_block__prompt_kernel
  .amdhsa_next_free_vgpr 256
  .amdhsa_next_free_sgpr 82
  .amdhsa_accum_offset 192
  .amdhsa_group_segment_fixed_size 0
  .amdhsa_kernarg_size 120
  .amdhsa_user_sgpr_count 2
  .amdhsa_user_sgpr_kernarg_segment_ptr 1
  .amdhsa_system_sgpr_workgroup_id_x 1
.end_amdhsa_kernel
```
